```python
import torch

def _softmax(x, axis=-1):
    return torch.softmax(x, dim=axis)
def _gelu(x):
    return torch.nn.functional.gelu(x, approximate="tanh")
def _silu(x):
    return torch.nn.functional.silu(x)
def _sigmoid(x):
    return torch.sigmoid(x)
def _layernorm(x, axis=-1, eps=1e-5):
    m = x.mean(dim=axis, keepdim=True)
    v = x.var(dim=axis, keepdim=True, unbiased=False)
    return (x - m) / torch.sqrt(v + eps)
def _scatter_add(tgt, idx, src, axis=0):
    return tgt.clone().index_add_(axis, idx, src)
def _segment_sum(src, seg, n):
    out = torch.zeros((n,) + src.shape[1:], dtype=src.dtype)
    return out.index_add_(0, seg, src)
def _pad(x, pw):
    flat = tuple(v for pair in reversed(pw) for v in pair)
    return torch.nn.functional.pad(x, flat)

kernel_name = 'standalone__mha_block_cached__near_ridge'

def setup_inputs():

    _w = (lambda a: (lambda t: t.to(torch.bfloat16) if t.is_floating_point() else t)(torch.as_tensor(a)))
    B, Sq, D = 16, 64, 1024
    H, Sk, Dh = 32, 512, 128
    return {
        "x": _w((lambda *s: torch.randn(*s, dtype=torch.bfloat16) * 0.8)(B, Sq, D)),
        "k_cache": _w((lambda *s: torch.randn(*s, dtype=torch.bfloat16) * 0.8)(B, H, Sk, Dh)),
        "v_cache": _w((lambda *s: torch.randn(*s, dtype=torch.bfloat16) * 0.05)(B, H, Sk, Dh)),
        "wq": _w((lambda *s: torch.randn(*s, dtype=torch.bfloat16) * 0.8)(D, H * Dh) * (D ** -0.5)),
        "wo": _w((lambda *s: torch.randn(*s, dtype=torch.bfloat16) * 0.05)(H * Dh, D) * ((H * Dh) ** -0.5)),
    }

def reference(x, k_cache, v_cache, wq, wo):
    B, Sq, D = x.shape
    H, Dh = 32, 128
    q = (lambda x, *d: x.permute(*d))((x @ wq).reshape(B, Sq, H, Dh), 0, 2, 1, 3)
    scores = torch.einsum("bhqd,bhkd->bhqk", q, k_cache) * (Dh ** -0.5)
    p = _softmax(scores, axis=-1)
    o = torch.einsum("bhqk,bhkd->bhqd", p, v_cache)
    return (lambda x, *d: x.permute(*d))(o, 0, 2, 1, 3).reshape(B, Sq, H * Dh) @ wo
```

```asm
; @launch grid=(256,1,1) block=(256,1,1) lds=163840
.amdgcn_target "amdgcn-amd-amdhsa--gfx950"
.text
.globl standalone__mha_block_cached__near_ridge_kernel
.p2align 8
.type standalone__mha_block_cached__near_ridge_kernel,@function
standalone__mha_block_cached__near_ridge_kernel:
    s_cmp_ge_u32 s2, 256
    s_cbranch_scc1 L_end
    s_load_dwordx8 s[4:11], s[0:1], 0
    s_load_dwordx8 s[12:19], s[0:1], 32
    s_memrealtime s[68:69]
    v_lshrrev_b32 v2, 6, v0
    v_and_b32 v1, 63, v0
    v_readfirstlane_b32 s3, v2
    s_and_b32 s52, s2, 3
    s_xor_b32 s52, s52, 3
    s_bfe_u32 s53, s2, 0x10002
    s_bfe_u32 s55, s2, 0x30003
    s_lshr_b32 s54, s2, 6
    s_lshl_b32 s44, s55, 2
    s_add_u32 s44, s44, s52
    s_lshl_b32 s45, s54, 1
    s_add_u32 s45, s45, s53
    s_lshl_b32 s46, s55, 1
    s_lshl_b32 s51, s54, 2
    s_add_u32 s46, s46, s51
    s_lshl_b32 s51, s53, 1
    s_add_u32 s46, s46, s51
    s_and_b32 s51, s52, 1
    s_add_u32 s46, s46, s51
    v_lshrrev_b32 v44, 4, v1
    v_and_b32 v45, 15, v1
    s_and_b32 s58, s3, 1
    s_lshr_b32 s59, s3, 1
    s_mul_i32 s50, s59, 81920
    s_lshl_b32 s51, s58, 13
    s_add_u32 s57, s50, s51
    s_lshl_b32 s61, s3, 12
    s_lshl_b32 s47, s45, 2
    s_add_u32 s47, s47, s3
    s_lshl_b32 s43, s47, 16
    s_lshl_b32 s48, s44, 8
    s_lshl_b32 s51, s3, 17
    s_add_u32 s48, s48, s51
    s_lshl_b32 s49, s45, 1
    s_add_u32 s49, s49, s59
    s_lshl_b32 s49, s49, 5
    s_add_u32 s49, s49, s44
    s_lshl_b32 s49, s49, 17
    s_lshl_b32 s51, s58, 13
    s_add_u32 s49, s49, s51
    s_mov_b32 s60, s43
    v_and_b32 v33, 7, v1
    v_xor_b32 v32, v44, v33
    v_lshlrev_b32 v32, 4, v32
    v_lshrrev_b32 v34, 3, v1
    v_lshl_add_u32 v2, v34, 11, v32
    v_xor_b32 v3, 64, v2
    v_lshlrev_b32 v32, 2, v44
    v_xor_b32 v32, v32, v45
    v_lshlrev_b32 v32, 4, v32
    v_lshl_add_u32 v9, v44, 13, v32
    v_lshl_add_u32 v8, v44, 8, v32
    v_xor_b32 v32, v44, v45
    v_lshlrev_b32 v32, 4, v32
    v_lshl_add_u32 v4, v44, 8, v32
    v_xor_b32 v5, 64, v4
    v_xor_b32 v6, 128, v4
    v_xor_b32 v7, 192, v4
    s_waitcnt lgkmcnt(0)
    s_mov_b32 s20, s4
    s_mov_b32 s21, s5
    s_mov_b32 s22, 2097152
    s_mov_b32 s23, 0x20000
    s_mov_b32 s32, s10
    s_mov_b32 s33, s11
    s_mov_b32 s34, 8388608
    s_mov_b32 s35, 0x20000
    s_mov_b32 s24, s6
    s_mov_b32 s25, s7
    s_mov_b32 s26, 67108864
    s_mov_b32 s27, 0x20000
    s_mov_b32 s28, s8
    s_mov_b32 s29, s9
    s_mov_b32 s30, 67108864
    s_mov_b32 s31, 0x20000
    s_add_u32 s63, s46, 0
    s_and_b32 s63, s63, 15
    s_lshl_b32 s64, s63, 7
    s_add_u32 s64, s64, s60
    s_lshl_b32 s65, s63, 19
    s_add_u32 s65, s65, s48
    s_add_u32 m0, s61, 32768
    s_nop 0
    buffer_load_dwordx4 v2, s[20:23], s64 offen sc1 lds
    s_add_u32 m0, s61, 33792
    s_add_u32 s66, s64, 16384
    buffer_load_dwordx4 v3, s[20:23], s66 offen sc1 lds
    s_add_u32 m0, s61, 34816
    s_add_u32 s66, s64, 32768
    buffer_load_dwordx4 v2, s[20:23], s66 offen sc1 lds
    s_add_u32 m0, s61, 35840
    s_add_u32 s66, s64, 49152
    buffer_load_dwordx4 v3, s[20:23], s66 offen sc1 lds
    s_add_u32 m0, s61, 114688
    s_nop 0
    buffer_load_dwordx4 v9, s[32:35], s65 offen sc1 lds
    s_add_u32 m0, s61, 115712
    s_add_u32 s66, s65, 32768
    buffer_load_dwordx4 v9, s[32:35], s66 offen sc1 lds
    s_add_u32 m0, s61, 116736
    s_add_u32 s66, s65, 65536
    buffer_load_dwordx4 v9, s[32:35], s66 offen sc1 lds
    s_add_u32 m0, s61, 117760
    s_add_u32 s66, s65, 98304
    buffer_load_dwordx4 v9, s[32:35], s66 offen sc1 lds
    s_add_u32 s63, s46, 1
    s_and_b32 s63, s63, 15
    s_lshl_b32 s64, s63, 7
    s_add_u32 s64, s64, s60
    s_lshl_b32 s65, s63, 19
    s_add_u32 s65, s65, s48
    s_add_u32 m0, s61, 49152
    s_nop 0
    buffer_load_dwordx4 v2, s[20:23], s64 offen sc1 lds
    s_add_u32 m0, s61, 50176
    s_add_u32 s66, s64, 16384
    buffer_load_dwordx4 v3, s[20:23], s66 offen sc1 lds
    s_add_u32 m0, s61, 51200
    s_add_u32 s66, s64, 32768
    buffer_load_dwordx4 v2, s[20:23], s66 offen sc1 lds
    s_add_u32 m0, s61, 52224
    s_add_u32 s66, s64, 49152
    buffer_load_dwordx4 v3, s[20:23], s66 offen sc1 lds
    s_add_u32 m0, s61, 131072
    s_nop 0
    buffer_load_dwordx4 v9, s[32:35], s65 offen sc1 lds
    s_add_u32 m0, s61, 132096
    s_add_u32 s66, s65, 32768
    buffer_load_dwordx4 v9, s[32:35], s66 offen sc1 lds
    s_add_u32 m0, s61, 133120
    s_add_u32 s66, s65, 65536
    buffer_load_dwordx4 v9, s[32:35], s66 offen sc1 lds
    s_add_u32 m0, s61, 134144
    s_add_u32 s66, s65, 98304
    buffer_load_dwordx4 v9, s[32:35], s66 offen sc1 lds
    s_mov_b32 s36, s18
    s_mov_b32 s37, s19
    s_mov_b32 s38, 50331648
    s_mov_b32 s39, 0x20000
    s_mov_b32 s40, s12
    s_mov_b32 s41, s13
    s_mov_b32 s42, 8388608
    s_mov_b32 s43, 0x20000
    v_lshrrev_b32 v40, 5, v1
    v_bfe_u32 v41, v1, 4, 1
    v_bfe_u32 v42, v1, 2, 2
    v_and_b32 v43, 3, v1
    v_and_b32 v46, 31, v1
    v_lshl_add_u32 v11, v1, 4, s57
    v_add_u32 v47, 65536, v11
    v_bfe_u32 v33, v1, 1, 3
    v_xor_b32 v33, v33, v40
    v_lshlrev_b32 v33, 4, v33
    v_lshl_add_u32 v33, v46, 7, v33
    s_add_u32 s51, s61, 32768
    v_xor_b32 v32, 0, v33
    v_add_u32 v12, s51, v32
    v_xor_b32 v32, 32, v33
    v_add_u32 v13, s51, v32
    v_xor_b32 v32, 64, v33
    v_add_u32 v14, s51, v32
    v_xor_b32 v32, 96, v33
    v_add_u32 v15, s51, v32
    v_and_b32 v34, 1, v43
    v_lshlrev_b32 v34, 1, v34
    v_lshrrev_b32 v35, 1, v43
    v_or_b32 v39, v34, v35
    v_lshl_add_u32 v33, v40, 3, v42
    v_lshlrev_b32 v33, 8, v33
    v_lshl_add_u32 v33, v41, 5, v33
    v_lshl_add_u32 v33, v39, 3, v33
    v_lshl_add_u32 v33, v42, 6, v33
    v_xor_b32 v32, 0, v33
    v_add_u32 v16, 114688, v32
    v_xor_b32 v32, 64, v33
    v_add_u32 v17, 114688, v32
    v_xor_b32 v32, 128, v33
    v_add_u32 v18, 114688, v32
    v_xor_b32 v32, 192, v33
    v_add_u32 v19, 114688, v32
    v_xor_b32 v33, v40, v45
    v_lshlrev_b32 v33, 4, v33
    v_lshl_add_u32 v33, v46, 8, v33
    v_xor_b32 v32, 0, v33
    v_add_u32 v20, s50, v32
    v_xor_b32 v32, 32, v33
    v_add_u32 v21, s50, v32
    v_xor_b32 v32, 64, v33
    v_add_u32 v22, s50, v32
    v_xor_b32 v32, 96, v33
    v_add_u32 v23, s50, v32
    v_xor_b32 v32, 128, v33
    v_add_u32 v24, s50, v32
    v_xor_b32 v32, 160, v33
    v_add_u32 v25, s50, v32
    v_xor_b32 v32, 192, v33
    v_add_u32 v26, s50, v32
    v_xor_b32 v32, 224, v33
    v_add_u32 v27, s50, v32
    v_lshl_add_u32 v33, v40, 2, v42
    v_lshlrev_b32 v33, 8, v33
    v_lshl_add_u32 v33, v41, 5, v33
    v_lshl_add_u32 v33, v43, 3, v33
    v_lshl_add_u32 v33, v42, 6, v33
    v_xor_b32 v32, 0, v33
    v_add_u32 v28, s50, v32
    v_xor_b32 v32, 64, v33
    v_add_u32 v29, s50, v32
    v_xor_b32 v32, 128, v33
    v_add_u32 v30, s50, v32
    v_xor_b32 v32, 192, v33
    v_add_u32 v31, s50, v32
    s_mov_b32 s72, 0x3e0293ee
    s_mov_b32 s73, 0x3e0293ee
    s_lshl_b32 s74, s55, 8
    v_mov_b32 v0, 0
    s_or_b32 s62, s2, s3
    s_cbranch_scc1 L_nopub
    s_or_b32 s68, s68, 1
    v_mov_b32 v36, s68
    s_mov_b64 exec, 1
    global_store_dword v0, v36, s[16:17] sc1
    s_mov_b64 exec, -1
L_nopub:
    s_getreg_b32 s69, hwreg(HW_REG_XCC_ID, 0, 3)
    s_lshl_b32 s69, s69, 2
    s_lshl_b32 s62, s45, 2
    s_add_u32 s62, s62, s52
    s_lshl_b32 s62, s62, 2
    s_add_u32 s62, s62, 4
    v_mov_b32 v37, s62
    v_cmp_eq_u32 vcc, 1, v1
    s_nop 1
    v_cndmask_b32 v0, 0, v37, vcc
    s_cmp_lg_u32 s3, 0
    s_cbranch_scc1 L_nocen
    s_lshl_b32 s62, 1, s69
    v_mov_b32 v38, s62
    s_mov_b64 exec, 1
    global_atomic_add v37, v38, s[16:17] sc1
    s_mov_b64 exec, -1
L_nocen:
    s_waitcnt vmcnt(8)
    s_barrier
    ds_read_b128 a[32:35], v12 offset:0
    ds_read_b64_tr_b16 a[0:1], v16 offset:0
    ds_read_b64_tr_b16 a[2:3], v16 offset:1024
    ds_read_b64_tr_b16 a[4:5], v17 offset:0
    ds_read_b64_tr_b16 a[6:7], v17 offset:1024
    ds_read_b64_tr_b16 a[8:9], v18 offset:0
    ds_read_b64_tr_b16 a[10:11], v18 offset:1024
    ds_read_b64_tr_b16 a[12:13], v19 offset:0
    ds_read_b64_tr_b16 a[14:15], v19 offset:1024
    s_add_u32 s63, s46, 2
    s_and_b32 s63, s63, 15
    s_lshl_b32 s64, s63, 7
    s_add_u32 s64, s64, s60
    s_lshl_b32 s65, s63, 19
    s_add_u32 s65, s65, s48
    s_add_u32 m0, s61, 65536
    s_nop 0
    buffer_load_dwordx4 v2, s[20:23], s64 offen sc1 lds
    s_add_u32 m0, s61, 66560
    s_add_u32 s66, s64, 16384
    buffer_load_dwordx4 v3, s[20:23], s66 offen sc1 lds
    s_waitcnt lgkmcnt(6)
    v_mfma_f32_32x32x16_bf16 v[64:79], a[0:3], a[32:35], 0
    ds_read_b128 a[36:39], v13 offset:0
    ds_read_b64_tr_b16 a[16:17], v16 offset:4096
    ds_read_b64_tr_b16 a[18:19], v16 offset:5120
    s_add_u32 m0, s61, 67584
    s_add_u32 s66, s64, 32768
    buffer_load_dwordx4 v2, s[20:23], s66 offen sc1 lds
    s_waitcnt lgkmcnt(7)
    v_mfma_f32_32x32x16_bf16 v[80:95], a[4:7], a[32:35], 0
    ds_read_b64_tr_b16 a[20:21], v17 offset:4096
    ds_read_b64_tr_b16 a[22:23], v17 offset:5120
    s_waitcnt lgkmcnt(7)
    v_mfma_f32_32x32x16_bf16 v[96:111], a[8:11], a[32:35], 0
    ds_read_b64_tr_b16 a[24:25], v18 offset:4096
    ds_read_b64_tr_b16 a[26:27], v18 offset:5120
    s_add_u32 m0, s61, 68608
    s_add_u32 s66, s64, 49152
    buffer_load_dwordx4 v3, s[20:23], s66 offen sc1 lds
    s_waitcnt lgkmcnt(7)
    v_mfma_f32_32x32x16_bf16 v[112:127], a[12:15], a[32:35], 0
    ds_read_b64_tr_b16 a[28:29], v19 offset:4096
    ds_read_b64_tr_b16 a[30:31], v19 offset:5120
    s_waitcnt lgkmcnt(6)
    v_mfma_f32_32x32x16_bf16 v[64:79], a[16:19], a[36:39], v[64:79]
    ds_read_b128 a[32:35], v14 offset:0
    ds_read_b64_tr_b16 a[0:1], v16 offset:8192
    ds_read_b64_tr_b16 a[2:3], v16 offset:9216
    s_add_u32 m0, s61, 147456
    s_nop 0
    buffer_load_dwordx4 v9, s[32:35], s65 offen sc1 lds
    s_waitcnt lgkmcnt(7)
    v_mfma_f32_32x32x16_bf16 v[80:95], a[20:23], a[36:39], v[80:95]
    ds_read_b64_tr_b16 a[4:5], v17 offset:8192
    ds_read_b64_tr_b16 a[6:7], v17 offset:9216
    s_waitcnt lgkmcnt(7)
    v_mfma_f32_32x32x16_bf16 v[96:111], a[24:27], a[36:39], v[96:111]
    ds_read_b64_tr_b16 a[8:9], v18 offset:8192
    ds_read_b64_tr_b16 a[10:11], v18 offset:9216
    s_add_u32 m0, s61, 148480
    s_add_u32 s66, s65, 32768
    buffer_load_dwordx4 v9, s[32:35], s66 offen sc1 lds
    s_waitcnt lgkmcnt(7)
    v_mfma_f32_32x32x16_bf16 v[112:127], a[28:31], a[36:39], v[112:127]
    ds_read_b64_tr_b16 a[12:13], v19 offset:8192
    ds_read_b64_tr_b16 a[14:15], v19 offset:9216
    s_waitcnt lgkmcnt(6)
    v_mfma_f32_32x32x16_bf16 v[64:79], a[0:3], a[32:35], v[64:79]
    ds_read_b128 a[36:39], v15 offset:0
    ds_read_b64_tr_b16 a[16:17], v16 offset:12288
    ds_read_b64_tr_b16 a[18:19], v16 offset:13312
    s_add_u32 m0, s61, 149504
    s_add_u32 s66, s65, 65536
    buffer_load_dwordx4 v9, s[32:35], s66 offen sc1 lds
    s_waitcnt lgkmcnt(7)
    v_mfma_f32_32x32x16_bf16 v[80:95], a[4:7], a[32:35], v[80:95]
    ds_read_b64_tr_b16 a[20:21], v17 offset:12288
    ds_read_b64_tr_b16 a[22:23], v17 offset:13312
    s_waitcnt lgkmcnt(7)
    v_mfma_f32_32x32x16_bf16 v[96:111], a[8:11], a[32:35], v[96:111]
    ds_read_b64_tr_b16 a[24:25], v18 offset:12288
    ds_read_b64_tr_b16 a[26:27], v18 offset:13312
    s_add_u32 m0, s61, 150528
    s_add_u32 s66, s65, 98304
    buffer_load_dwordx4 v9, s[32:35], s66 offen sc1 lds
    s_waitcnt lgkmcnt(7)
    v_mfma_f32_32x32x16_bf16 v[112:127], a[12:15], a[32:35], v[112:127]
    ds_read_b64_tr_b16 a[28:29], v19 offset:12288
    ds_read_b64_tr_b16 a[30:31], v19 offset:13312
    s_waitcnt lgkmcnt(6)
    v_mfma_f32_32x32x16_bf16 v[64:79], a[16:19], a[36:39], v[64:79]
    s_waitcnt lgkmcnt(4)
    v_mfma_f32_32x32x16_bf16 v[80:95], a[20:23], a[36:39], v[80:95]
    s_waitcnt lgkmcnt(2)
    v_mfma_f32_32x32x16_bf16 v[96:111], a[24:27], a[36:39], v[96:111]
    s_waitcnt lgkmcnt(0)
    v_mfma_f32_32x32x16_bf16 v[112:127], a[28:31], a[36:39], v[112:127]
    s_waitcnt vmcnt(8)
    s_barrier
    ds_read_b128 a[32:35], v12 offset:16384
    ds_read_b64_tr_b16 a[0:1], v16 offset:16384
    ds_read_b64_tr_b16 a[2:3], v16 offset:17408
    ds_read_b64_tr_b16 a[4:5], v17 offset:16384
    ds_read_b64_tr_b16 a[6:7], v17 offset:17408
    ds_read_b64_tr_b16 a[8:9], v18 offset:16384
    ds_read_b64_tr_b16 a[10:11], v18 offset:17408
    ds_read_b64_tr_b16 a[12:13], v19 offset:16384
    ds_read_b64_tr_b16 a[14:15], v19 offset:17408
    s_add_u32 s63, s46, 3
    s_and_b32 s63, s63, 15
    s_lshl_b32 s64, s63, 7
    s_add_u32 s64, s64, s60
    s_lshl_b32 s65, s63, 19
    s_add_u32 s65, s65, s48
    s_add_u32 m0, s61, 32768
    s_nop 0
    buffer_load_dwordx4 v2, s[20:23], s64 offen sc1 lds
    s_add_u32 m0, s61, 33792
    s_add_u32 s66, s64, 16384
    buffer_load_dwordx4 v3, s[20:23], s66 offen sc1 lds
    s_waitcnt lgkmcnt(6)
    v_mfma_f32_32x32x16_bf16 v[64:79], a[0:3], a[32:35], v[64:79]
    ds_read_b128 a[36:39], v13 offset:16384
    ds_read_b64_tr_b16 a[16:17], v16 offset:20480
    ds_read_b64_tr_b16 a[18:19], v16 offset:21504
    s_add_u32 m0, s61, 34816
    s_add_u32 s66, s64, 32768
    buffer_load_dwordx4 v2, s[20:23], s66 offen sc1 lds
    s_waitcnt lgkmcnt(7)
    v_mfma_f32_32x32x16_bf16 v[80:95], a[4:7], a[32:35], v[80:95]
    ds_read_b64_tr_b16 a[20:21], v17 offset:20480
    ds_read_b64_tr_b16 a[22:23], v17 offset:21504
    s_waitcnt lgkmcnt(7)
    v_mfma_f32_32x32x16_bf16 v[96:111], a[8:11], a[32:35], v[96:111]
    ds_read_b64_tr_b16 a[24:25], v18 offset:20480
    ds_read_b64_tr_b16 a[26:27], v18 offset:21504
    s_add_u32 m0, s61, 35840
    s_add_u32 s66, s64, 49152
    buffer_load_dwordx4 v3, s[20:23], s66 offen sc1 lds
    s_waitcnt lgkmcnt(7)
    v_mfma_f32_32x32x16_bf16 v[112:127], a[12:15], a[32:35], v[112:127]
    ds_read_b64_tr_b16 a[28:29], v19 offset:20480
    ds_read_b64_tr_b16 a[30:31], v19 offset:21504
    s_waitcnt lgkmcnt(6)
    v_mfma_f32_32x32x16_bf16 v[64:79], a[16:19], a[36:39], v[64:79]
    ds_read_b128 a[32:35], v14 offset:16384
    ds_read_b64_tr_b16 a[0:1], v16 offset:24576
    ds_read_b64_tr_b16 a[2:3], v16 offset:25600
    s_add_u32 m0, s61, 114688
    s_nop 0
    buffer_load_dwordx4 v9, s[32:35], s65 offen sc1 lds
    s_waitcnt lgkmcnt(7)
    v_mfma_f32_32x32x16_bf16 v[80:95], a[20:23], a[36:39], v[80:95]
    ds_read_b64_tr_b16 a[4:5], v17 offset:24576
    ds_read_b64_tr_b16 a[6:7], v17 offset:25600
    s_waitcnt lgkmcnt(7)
    v_mfma_f32_32x32x16_bf16 v[96:111], a[24:27], a[36:39], v[96:111]
    ds_read_b64_tr_b16 a[8:9], v18 offset:24576
    ds_read_b64_tr_b16 a[10:11], v18 offset:25600
    s_add_u32 m0, s61, 115712
    s_add_u32 s66, s65, 32768
    buffer_load_dwordx4 v9, s[32:35], s66 offen sc1 lds
    s_waitcnt lgkmcnt(7)
    v_mfma_f32_32x32x16_bf16 v[112:127], a[28:31], a[36:39], v[112:127]
    ds_read_b64_tr_b16 a[12:13], v19 offset:24576
    ds_read_b64_tr_b16 a[14:15], v19 offset:25600
    s_waitcnt lgkmcnt(6)
    v_mfma_f32_32x32x16_bf16 v[64:79], a[0:3], a[32:35], v[64:79]
    ds_read_b128 a[36:39], v15 offset:16384
    ds_read_b64_tr_b16 a[16:17], v16 offset:28672
    ds_read_b64_tr_b16 a[18:19], v16 offset:29696
    s_add_u32 m0, s61, 116736
    s_add_u32 s66, s65, 65536
    buffer_load_dwordx4 v9, s[32:35], s66 offen sc1 lds
    s_waitcnt lgkmcnt(7)
    v_mfma_f32_32x32x16_bf16 v[80:95], a[4:7], a[32:35], v[80:95]
    ds_read_b64_tr_b16 a[20:21], v17 offset:28672
    ds_read_b64_tr_b16 a[22:23], v17 offset:29696
    s_waitcnt lgkmcnt(7)
    v_mfma_f32_32x32x16_bf16 v[96:111], a[8:11], a[32:35], v[96:111]
    ds_read_b64_tr_b16 a[24:25], v18 offset:28672
    ds_read_b64_tr_b16 a[26:27], v18 offset:29696
    s_add_u32 m0, s61, 117760
    s_add_u32 s66, s65, 98304
    buffer_load_dwordx4 v9, s[32:35], s66 offen sc1 lds
    s_waitcnt lgkmcnt(7)
    v_mfma_f32_32x32x16_bf16 v[112:127], a[12:15], a[32:35], v[112:127]
    ds_read_b64_tr_b16 a[28:29], v19 offset:28672
    ds_read_b64_tr_b16 a[30:31], v19 offset:29696
    s_waitcnt lgkmcnt(6)
    v_mfma_f32_32x32x16_bf16 v[64:79], a[16:19], a[36:39], v[64:79]
    s_waitcnt lgkmcnt(4)
    v_mfma_f32_32x32x16_bf16 v[80:95], a[20:23], a[36:39], v[80:95]
    s_waitcnt lgkmcnt(2)
    v_mfma_f32_32x32x16_bf16 v[96:111], a[24:27], a[36:39], v[96:111]
    s_waitcnt lgkmcnt(0)
    v_mfma_f32_32x32x16_bf16 v[112:127], a[28:31], a[36:39], v[112:127]
    s_waitcnt vmcnt(8)
    s_barrier
    ds_read_b128 a[32:35], v12 offset:32768
    ds_read_b64_tr_b16 a[0:1], v16 offset:32768
    ds_read_b64_tr_b16 a[2:3], v16 offset:33792
    ds_read_b64_tr_b16 a[4:5], v17 offset:32768
    ds_read_b64_tr_b16 a[6:7], v17 offset:33792
    ds_read_b64_tr_b16 a[8:9], v18 offset:32768
    ds_read_b64_tr_b16 a[10:11], v18 offset:33792
    ds_read_b64_tr_b16 a[12:13], v19 offset:32768
    ds_read_b64_tr_b16 a[14:15], v19 offset:33792
    s_add_u32 s67, s49, 0
    s_add_u32 m0, s57, 0
    s_nop 0
    buffer_load_dwordx4 v4, s[24:27], s67 offen nt lds
    buffer_load_dwordx4 v5, s[24:27], s67 offen offset:1024 nt lds
    buffer_load_dwordx4 v6, s[24:27], s67 offen offset:2048 nt lds
    buffer_load_dwordx4 v7, s[24:27], s67 offen offset:3072 nt lds
    s_waitcnt lgkmcnt(6)
    v_mfma_f32_32x32x16_bf16 v[64:79], a[0:3], a[32:35], v[64:79]
    ds_read_b128 a[36:39], v13 offset:32768
    ds_read_b64_tr_b16 a[16:17], v16 offset:36864
    ds_read_b64_tr_b16 a[18:19], v16 offset:37888
    s_add_u32 s67, s49, 4096
    s_add_u32 m0, s57, 4096
    s_nop 0
    buffer_load_dwordx4 v4, s[24:27], s67 offen nt lds
    s_waitcnt lgkmcnt(7)
    v_mfma_f32_32x32x16_bf16 v[80:95], a[4:7], a[32:35], v[80:95]
    ds_read_b64_tr_b16 a[20:21], v17 offset:36864
    ds_read_b64_tr_b16 a[22:23], v17 offset:37888
    buffer_load_dwordx4 v5, s[24:27], s67 offen offset:1024 nt lds
    s_waitcnt lgkmcnt(7)
    v_mfma_f32_32x32x16_bf16 v[96:111], a[8:11], a[32:35], v[96:111]
    ds_read_b64_tr_b16 a[24:25], v18 offset:36864
    ds_read_b64_tr_b16 a[26:27], v18 offset:37888
    s_add_u32 s63, s46, 4
    s_and_b32 s63, s63, 15
    s_lshl_b32 s64, s63, 7
    s_add_u32 s64, s64, s60
    s_lshl_b32 s65, s63, 19
    s_add_u32 s65, s65, s48
    s_add_u32 m0, s61, 49152
    s_nop 0
    buffer_load_dwordx4 v2, s[20:23], s64 offen sc1 lds
    s_waitcnt lgkmcnt(7)
    v_mfma_f32_32x32x16_bf16 v[112:127], a[12:15], a[32:35], v[112:127]
    ds_read_b64_tr_b16 a[28:29], v19 offset:36864
    ds_read_b64_tr_b16 a[30:31], v19 offset:37888
    s_add_u32 m0, s61, 50176
    s_add_u32 s66, s64, 16384
    buffer_load_dwordx4 v3, s[20:23], s66 offen sc1 lds
    s_waitcnt lgkmcnt(6)
    v_mfma_f32_32x32x16_bf16 v[64:79], a[16:19], a[36:39], v[64:79]
    ds_read_b128 a[32:35], v14 offset:32768
    ds_read_b64_tr_b16 a[0:1], v16 offset:40960
    ds_read_b64_tr_b16 a[2:3], v16 offset:41984
    s_add_u32 m0, s61, 51200
    s_add_u32 s66, s64, 32768
    buffer_load_dwordx4 v2, s[20:23], s66 offen sc1 lds
    s_waitcnt lgkmcnt(7)
    v_mfma_f32_32x32x16_bf16 v[80:95], a[20:23], a[36:39], v[80:95]
    ds_read_b64_tr_b16 a[4:5], v17 offset:40960
    ds_read_b64_tr_b16 a[6:7], v17 offset:41984
    s_waitcnt lgkmcnt(7)
    v_mfma_f32_32x32x16_bf16 v[96:111], a[24:27], a[36:39], v[96:111]
    ds_read_b64_tr_b16 a[8:9], v18 offset:40960
    ds_read_b64_tr_b16 a[10:11], v18 offset:41984
    s_add_u32 m0, s61, 52224
    s_add_u32 s66, s64, 49152
    buffer_load_dwordx4 v3, s[20:23], s66 offen sc1 lds
    s_waitcnt lgkmcnt(7)
    v_mfma_f32_32x32x16_bf16 v[112:127], a[28:31], a[36:39], v[112:127]
    ds_read_b64_tr_b16 a[12:13], v19 offset:40960
    ds_read_b64_tr_b16 a[14:15], v19 offset:41984
    s_add_u32 m0, s61, 131072
    s_nop 0
    buffer_load_dwordx4 v9, s[32:35], s65 offen sc1 lds
    s_waitcnt lgkmcnt(6)
    v_mfma_f32_32x32x16_bf16 v[64:79], a[0:3], a[32:35], v[64:79]
    ds_read_b128 a[36:39], v15 offset:32768
    ds_read_b64_tr_b16 a[16:17], v16 offset:45056
    ds_read_b64_tr_b16 a[18:19], v16 offset:46080
    s_add_u32 m0, s61, 132096
    s_add_u32 s66, s65, 32768
    buffer_load_dwordx4 v9, s[32:35], s66 offen sc1 lds
    s_waitcnt lgkmcnt(7)
    v_mfma_f32_32x32x16_bf16 v[80:95], a[4:7], a[32:35], v[80:95]
    ds_read_b64_tr_b16 a[20:21], v17 offset:45056
    ds_read_b64_tr_b16 a[22:23], v17 offset:46080
    s_add_u32 m0, s61, 133120
    s_add_u32 s66, s65, 65536
    buffer_load_dwordx4 v9, s[32:35], s66 offen sc1 lds
    s_waitcnt lgkmcnt(7)
    v_mfma_f32_32x32x16_bf16 v[96:111], a[8:11], a[32:35], v[96:111]
    ds_read_b64_tr_b16 a[24:25], v18 offset:45056
    ds_read_b64_tr_b16 a[26:27], v18 offset:46080
    s_add_u32 m0, s61, 134144
    s_add_u32 s66, s65, 98304
    buffer_load_dwordx4 v9, s[32:35], s66 offen sc1 lds
    s_waitcnt lgkmcnt(7)
    v_mfma_f32_32x32x16_bf16 v[112:127], a[12:15], a[32:35], v[112:127]
    ds_read_b64_tr_b16 a[28:29], v19 offset:45056
    ds_read_b64_tr_b16 a[30:31], v19 offset:46080
    s_waitcnt lgkmcnt(6)
    v_mfma_f32_32x32x16_bf16 v[64:79], a[16:19], a[36:39], v[64:79]
    s_waitcnt lgkmcnt(4)
    v_mfma_f32_32x32x16_bf16 v[80:95], a[20:23], a[36:39], v[80:95]
    s_waitcnt lgkmcnt(2)
    v_mfma_f32_32x32x16_bf16 v[96:111], a[24:27], a[36:39], v[96:111]
    s_waitcnt lgkmcnt(0)
    v_mfma_f32_32x32x16_bf16 v[112:127], a[28:31], a[36:39], v[112:127]
    s_waitcnt vmcnt(14)
    s_barrier
    ds_read_b128 a[32:35], v12 offset:0
    ds_read_b64_tr_b16 a[0:1], v16 offset:0
    ds_read_b64_tr_b16 a[2:3], v16 offset:1024
    ds_read_b64_tr_b16 a[4:5], v17 offset:0
    ds_read_b64_tr_b16 a[6:7], v17 offset:1024
    ds_read_b64_tr_b16 a[8:9], v18 offset:0
    ds_read_b64_tr_b16 a[10:11], v18 offset:1024
    ds_read_b64_tr_b16 a[12:13], v19 offset:0
    ds_read_b64_tr_b16 a[14:15], v19 offset:1024
    s_add_u32 s63, s46, 5
    s_and_b32 s63, s63, 15
    s_lshl_b32 s64, s63, 7
    s_add_u32 s64, s64, s60
    s_lshl_b32 s65, s63, 19
    s_add_u32 s65, s65, s48
    s_add_u32 m0, s61, 65536
    s_nop 0
    buffer_load_dwordx4 v2, s[20:23], s64 offen sc1 lds
    s_add_u32 m0, s61, 66560
    s_add_u32 s66, s64, 16384
    buffer_load_dwordx4 v3, s[20:23], s66 offen sc1 lds
    s_waitcnt lgkmcnt(6)
    v_mfma_f32_32x32x16_bf16 v[64:79], a[0:3], a[32:35], v[64:79]
    ds_read_b128 a[36:39], v13 offset:0
    ds_read_b64_tr_b16 a[16:17], v16 offset:4096
    ds_read_b64_tr_b16 a[18:19], v16 offset:5120
    s_add_u32 m0, s61, 67584
    s_add_u32 s66, s64, 32768
    buffer_load_dwordx4 v2, s[20:23], s66 offen sc1 lds
    s_waitcnt lgkmcnt(7)
    v_mfma_f32_32x32x16_bf16 v[80:95], a[4:7], a[32:35], v[80:95]
    ds_read_b64_tr_b16 a[20:21], v17 offset:4096
    ds_read_b64_tr_b16 a[22:23], v17 offset:5120
    s_waitcnt lgkmcnt(7)
    v_mfma_f32_32x32x16_bf16 v[96:111], a[8:11], a[32:35], v[96:111]
    ds_read_b64_tr_b16 a[24:25], v18 offset:4096
    ds_read_b64_tr_b16 a[26:27], v18 offset:5120
    s_add_u32 m0, s61, 68608
    s_add_u32 s66, s64, 49152
    buffer_load_dwordx4 v3, s[20:23], s66 offen sc1 lds
    s_waitcnt lgkmcnt(7)
    v_mfma_f32_32x32x16_bf16 v[112:127], a[12:15], a[32:35], v[112:127]
    ds_read_b64_tr_b16 a[28:29], v19 offset:4096
    ds_read_b64_tr_b16 a[30:31], v19 offset:5120
    s_waitcnt lgkmcnt(6)
    v_mfma_f32_32x32x16_bf16 v[64:79], a[16:19], a[36:39], v[64:79]
    ds_read_b128 a[32:35], v14 offset:0
    ds_read_b64_tr_b16 a[0:1], v16 offset:8192
    ds_read_b64_tr_b16 a[2:3], v16 offset:9216
    s_add_u32 m0, s61, 147456
    s_nop 0
    buffer_load_dwordx4 v9, s[32:35], s65 offen sc1 lds
    s_waitcnt lgkmcnt(7)
    v_mfma_f32_32x32x16_bf16 v[80:95], a[20:23], a[36:39], v[80:95]
    ds_read_b64_tr_b16 a[4:5], v17 offset:8192
    ds_read_b64_tr_b16 a[6:7], v17 offset:9216
    s_waitcnt lgkmcnt(7)
    v_mfma_f32_32x32x16_bf16 v[96:111], a[24:27], a[36:39], v[96:111]
    ds_read_b64_tr_b16 a[8:9], v18 offset:8192
    ds_read_b64_tr_b16 a[10:11], v18 offset:9216
    s_add_u32 m0, s61, 148480
    s_add_u32 s66, s65, 32768
    buffer_load_dwordx4 v9, s[32:35], s66 offen sc1 lds
    s_waitcnt lgkmcnt(7)
    v_mfma_f32_32x32x16_bf16 v[112:127], a[28:31], a[36:39], v[112:127]
    ds_read_b64_tr_b16 a[12:13], v19 offset:8192
    ds_read_b64_tr_b16 a[14:15], v19 offset:9216
    s_waitcnt lgkmcnt(6)
    v_mfma_f32_32x32x16_bf16 v[64:79], a[0:3], a[32:35], v[64:79]
    ds_read_b128 a[36:39], v15 offset:0
    ds_read_b64_tr_b16 a[16:17], v16 offset:12288
    ds_read_b64_tr_b16 a[18:19], v16 offset:13312
    s_add_u32 m0, s61, 149504
    s_add_u32 s66, s65, 65536
    buffer_load_dwordx4 v9, s[32:35], s66 offen sc1 lds
    s_waitcnt lgkmcnt(7)
    v_mfma_f32_32x32x16_bf16 v[80:95], a[4:7], a[32:35], v[80:95]
    ds_read_b64_tr_b16 a[20:21], v17 offset:12288
    ds_read_b64_tr_b16 a[22:23], v17 offset:13312
    s_waitcnt lgkmcnt(7)
    v_mfma_f32_32x32x16_bf16 v[96:111], a[8:11], a[32:35], v[96:111]
    ds_read_b64_tr_b16 a[24:25], v18 offset:12288
    ds_read_b64_tr_b16 a[26:27], v18 offset:13312
    s_add_u32 m0, s61, 150528
    s_add_u32 s66, s65, 98304
    buffer_load_dwordx4 v9, s[32:35], s66 offen sc1 lds
    s_waitcnt lgkmcnt(7)
    v_mfma_f32_32x32x16_bf16 v[112:127], a[12:15], a[32:35], v[112:127]
    ds_read_b64_tr_b16 a[28:29], v19 offset:12288
    ds_read_b64_tr_b16 a[30:31], v19 offset:13312
    s_waitcnt lgkmcnt(6)
    v_mfma_f32_32x32x16_bf16 v[64:79], a[16:19], a[36:39], v[64:79]
    s_waitcnt lgkmcnt(4)
    v_mfma_f32_32x32x16_bf16 v[80:95], a[20:23], a[36:39], v[80:95]
    s_waitcnt lgkmcnt(2)
    v_mfma_f32_32x32x16_bf16 v[96:111], a[24:27], a[36:39], v[96:111]
    s_waitcnt lgkmcnt(0)
    v_mfma_f32_32x32x16_bf16 v[112:127], a[28:31], a[36:39], v[112:127]
    s_waitcnt vmcnt(8)
    s_barrier
    ds_read_b128 a[32:35], v12 offset:16384
    ds_read_b64_tr_b16 a[0:1], v16 offset:16384
    ds_read_b64_tr_b16 a[2:3], v16 offset:17408
    ds_read_b64_tr_b16 a[4:5], v17 offset:16384
    ds_read_b64_tr_b16 a[6:7], v17 offset:17408
    ds_read_b64_tr_b16 a[8:9], v18 offset:16384
    ds_read_b64_tr_b16 a[10:11], v18 offset:17408
    ds_read_b64_tr_b16 a[12:13], v19 offset:16384
    ds_read_b64_tr_b16 a[14:15], v19 offset:17408
    s_add_u32 m0, s57, 4096
    s_nop 0
    buffer_load_dwordx4 v6, s[24:27], s67 offen offset:2048 nt lds
    buffer_load_dwordx4 v7, s[24:27], s67 offen offset:3072 nt lds
    s_add_u32 s67, s49, 16384
    s_add_u32 m0, s57, 16384
    s_nop 0
    buffer_load_dwordx4 v4, s[24:27], s67 offen nt lds
    buffer_load_dwordx4 v5, s[24:27], s67 offen offset:1024 nt lds
    s_waitcnt lgkmcnt(6)
    v_mfma_f32_32x32x16_bf16 v[64:79], a[0:3], a[32:35], v[64:79]
    ds_read_b128 a[36:39], v13 offset:16384
    ds_read_b64_tr_b16 a[16:17], v16 offset:20480
    ds_read_b64_tr_b16 a[18:19], v16 offset:21504
    buffer_load_dwordx4 v6, s[24:27], s67 offen offset:2048 nt lds
    s_waitcnt lgkmcnt(7)
    v_mfma_f32_32x32x16_bf16 v[80:95], a[4:7], a[32:35], v[80:95]
    ds_read_b64_tr_b16 a[20:21], v17 offset:20480
    ds_read_b64_tr_b16 a[22:23], v17 offset:21504
    buffer_load_dwordx4 v7, s[24:27], s67 offen offset:3072 nt lds
    s_waitcnt lgkmcnt(7)
    v_mfma_f32_32x32x16_bf16 v[96:111], a[8:11], a[32:35], v[96:111]
    ds_read_b64_tr_b16 a[24:25], v18 offset:20480
    ds_read_b64_tr_b16 a[26:27], v18 offset:21504
    s_add_u32 s63, s46, 6
    s_and_b32 s63, s63, 15
    s_lshl_b32 s64, s63, 7
    s_add_u32 s64, s64, s60
    s_lshl_b32 s65, s63, 19
    s_add_u32 s65, s65, s48
    s_add_u32 m0, s61, 32768
    s_nop 0
    buffer_load_dwordx4 v2, s[20:23], s64 offen sc1 lds
    s_waitcnt lgkmcnt(7)
    v_mfma_f32_32x32x16_bf16 v[112:127], a[12:15], a[32:35], v[112:127]
    ds_read_b64_tr_b16 a[28:29], v19 offset:20480
    ds_read_b64_tr_b16 a[30:31], v19 offset:21504
    s_add_u32 m0, s61, 33792
    s_add_u32 s66, s64, 16384
    buffer_load_dwordx4 v3, s[20:23], s66 offen sc1 lds
    s_waitcnt lgkmcnt(6)
    v_mfma_f32_32x32x16_bf16 v[64:79], a[16:19], a[36:39], v[64:79]
    ds_read_b128 a[32:35], v14 offset:16384
    ds_read_b64_tr_b16 a[0:1], v16 offset:24576
    ds_read_b64_tr_b16 a[2:3], v16 offset:25600
    s_add_u32 m0, s61, 34816
    s_add_u32 s66, s64, 32768
    buffer_load_dwordx4 v2, s[20:23], s66 offen sc1 lds
    s_waitcnt lgkmcnt(7)
    v_mfma_f32_32x32x16_bf16 v[80:95], a[20:23], a[36:39], v[80:95]
    ds_read_b64_tr_b16 a[4:5], v17 offset:24576
    ds_read_b64_tr_b16 a[6:7], v17 offset:25600
    s_waitcnt lgkmcnt(7)
    v_mfma_f32_32x32x16_bf16 v[96:111], a[24:27], a[36:39], v[96:111]
    ds_read_b64_tr_b16 a[8:9], v18 offset:24576
    ds_read_b64_tr_b16 a[10:11], v18 offset:25600
    s_add_u32 m0, s61, 35840
    s_add_u32 s66, s64, 49152
    buffer_load_dwordx4 v3, s[20:23], s66 offen sc1 lds
    s_waitcnt lgkmcnt(7)
    v_mfma_f32_32x32x16_bf16 v[112:127], a[28:31], a[36:39], v[112:127]
    ds_read_b64_tr_b16 a[12:13], v19 offset:24576
    ds_read_b64_tr_b16 a[14:15], v19 offset:25600
    s_add_u32 m0, s61, 114688
    s_nop 0
    buffer_load_dwordx4 v9, s[32:35], s65 offen sc1 lds
    s_waitcnt lgkmcnt(6)
    v_mfma_f32_32x32x16_bf16 v[64:79], a[0:3], a[32:35], v[64:79]
    ds_read_b128 a[36:39], v15 offset:16384
    ds_read_b64_tr_b16 a[16:17], v16 offset:28672
    ds_read_b64_tr_b16 a[18:19], v16 offset:29696
    s_add_u32 m0, s61, 115712
    s_add_u32 s66, s65, 32768
    buffer_load_dwordx4 v9, s[32:35], s66 offen sc1 lds
    s_waitcnt lgkmcnt(7)
    v_mfma_f32_32x32x16_bf16 v[80:95], a[4:7], a[32:35], v[80:95]
    ds_read_b64_tr_b16 a[20:21], v17 offset:28672
    ds_read_b64_tr_b16 a[22:23], v17 offset:29696
    s_add_u32 m0, s61, 116736
    s_add_u32 s66, s65, 65536
    buffer_load_dwordx4 v9, s[32:35], s66 offen sc1 lds
    s_waitcnt lgkmcnt(7)
    v_mfma_f32_32x32x16_bf16 v[96:111], a[8:11], a[32:35], v[96:111]
    ds_read_b64_tr_b16 a[24:25], v18 offset:28672
    ds_read_b64_tr_b16 a[26:27], v18 offset:29696
    s_add_u32 m0, s61, 117760
    s_add_u32 s66, s65, 98304
    buffer_load_dwordx4 v9, s[32:35], s66 offen sc1 lds
    s_waitcnt lgkmcnt(7)
    v_mfma_f32_32x32x16_bf16 v[112:127], a[12:15], a[32:35], v[112:127]
    ds_read_b64_tr_b16 a[28:29], v19 offset:28672
    ds_read_b64_tr_b16 a[30:31], v19 offset:29696
    s_waitcnt lgkmcnt(6)
    v_mfma_f32_32x32x16_bf16 v[64:79], a[16:19], a[36:39], v[64:79]
    s_waitcnt lgkmcnt(4)
    v_mfma_f32_32x32x16_bf16 v[80:95], a[20:23], a[36:39], v[80:95]
    s_waitcnt lgkmcnt(2)
    v_mfma_f32_32x32x16_bf16 v[96:111], a[24:27], a[36:39], v[96:111]
    s_waitcnt lgkmcnt(0)
    v_mfma_f32_32x32x16_bf16 v[112:127], a[28:31], a[36:39], v[112:127]
    s_waitcnt vmcnt(14)
    s_barrier
    ds_read_b128 a[32:35], v12 offset:32768
    ds_read_b64_tr_b16 a[0:1], v16 offset:32768
    ds_read_b64_tr_b16 a[2:3], v16 offset:33792
    ds_read_b64_tr_b16 a[4:5], v17 offset:32768
    ds_read_b64_tr_b16 a[6:7], v17 offset:33792
    ds_read_b64_tr_b16 a[8:9], v18 offset:32768
    ds_read_b64_tr_b16 a[10:11], v18 offset:33792
    ds_read_b64_tr_b16 a[12:13], v19 offset:32768
    ds_read_b64_tr_b16 a[14:15], v19 offset:33792
    s_add_u32 s63, s46, 7
    s_and_b32 s63, s63, 15
    s_lshl_b32 s64, s63, 7
    s_add_u32 s64, s64, s60
    s_lshl_b32 s65, s63, 19
    s_add_u32 s65, s65, s48
    s_add_u32 m0, s61, 49152
    s_nop 0
    buffer_load_dwordx4 v2, s[20:23], s64 offen sc1 lds
    s_add_u32 m0, s61, 50176
    s_add_u32 s66, s64, 16384
    buffer_load_dwordx4 v3, s[20:23], s66 offen sc1 lds
    s_waitcnt lgkmcnt(6)
    v_mfma_f32_32x32x16_bf16 v[64:79], a[0:3], a[32:35], v[64:79]
    ds_read_b128 a[36:39], v13 offset:32768
    ds_read_b64_tr_b16 a[16:17], v16 offset:36864
    ds_read_b64_tr_b16 a[18:19], v16 offset:37888
    s_add_u32 m0, s61, 51200
    s_add_u32 s66, s64, 32768
    buffer_load_dwordx4 v2, s[20:23], s66 offen sc1 lds
    s_waitcnt lgkmcnt(7)
    v_mfma_f32_32x32x16_bf16 v[80:95], a[4:7], a[32:35], v[80:95]
    ds_read_b64_tr_b16 a[20:21], v17 offset:36864
    ds_read_b64_tr_b16 a[22:23], v17 offset:37888
    s_waitcnt lgkmcnt(7)
    v_mfma_f32_32x32x16_bf16 v[96:111], a[8:11], a[32:35], v[96:111]
    ds_read_b64_tr_b16 a[24:25], v18 offset:36864
    ds_read_b64_tr_b16 a[26:27], v18 offset:37888
    s_add_u32 m0, s61, 52224
    s_add_u32 s66, s64, 49152
    buffer_load_dwordx4 v3, s[20:23], s66 offen sc1 lds
    s_waitcnt lgkmcnt(7)
    v_mfma_f32_32x32x16_bf16 v[112:127], a[12:15], a[32:35], v[112:127]
    ds_read_b64_tr_b16 a[28:29], v19 offset:36864
    ds_read_b64_tr_b16 a[30:31], v19 offset:37888
    s_waitcnt lgkmcnt(6)
    v_mfma_f32_32x32x16_bf16 v[64:79], a[16:19], a[36:39], v[64:79]
    ds_read_b128 a[32:35], v14 offset:32768
    ds_read_b64_tr_b16 a[0:1], v16 offset:40960
    ds_read_b64_tr_b16 a[2:3], v16 offset:41984
    s_add_u32 m0, s61, 131072
    s_nop 0
    buffer_load_dwordx4 v9, s[32:35], s65 offen sc1 lds
    s_waitcnt lgkmcnt(7)
    v_mfma_f32_32x32x16_bf16 v[80:95], a[20:23], a[36:39], v[80:95]
    ds_read_b64_tr_b16 a[4:5], v17 offset:40960
    ds_read_b64_tr_b16 a[6:7], v17 offset:41984
    s_waitcnt lgkmcnt(7)
    v_mfma_f32_32x32x16_bf16 v[96:111], a[24:27], a[36:39], v[96:111]
    ds_read_b64_tr_b16 a[8:9], v18 offset:40960
    ds_read_b64_tr_b16 a[10:11], v18 offset:41984
    s_add_u32 m0, s61, 132096
    s_add_u32 s66, s65, 32768
    buffer_load_dwordx4 v9, s[32:35], s66 offen sc1 lds
    s_waitcnt lgkmcnt(7)
    v_mfma_f32_32x32x16_bf16 v[112:127], a[28:31], a[36:39], v[112:127]
    ds_read_b64_tr_b16 a[12:13], v19 offset:40960
    ds_read_b64_tr_b16 a[14:15], v19 offset:41984
    s_waitcnt lgkmcnt(6)
    v_mfma_f32_32x32x16_bf16 v[64:79], a[0:3], a[32:35], v[64:79]
    ds_read_b128 a[36:39], v15 offset:32768
    ds_read_b64_tr_b16 a[16:17], v16 offset:45056
    ds_read_b64_tr_b16 a[18:19], v16 offset:46080
    s_add_u32 m0, s61, 133120
    s_add_u32 s66, s65, 65536
    buffer_load_dwordx4 v9, s[32:35], s66 offen sc1 lds
    s_waitcnt lgkmcnt(7)
    v_mfma_f32_32x32x16_bf16 v[80:95], a[4:7], a[32:35], v[80:95]
    ds_read_b64_tr_b16 a[20:21], v17 offset:45056
    ds_read_b64_tr_b16 a[22:23], v17 offset:46080
    s_waitcnt lgkmcnt(7)
    v_mfma_f32_32x32x16_bf16 v[96:111], a[8:11], a[32:35], v[96:111]
    ds_read_b64_tr_b16 a[24:25], v18 offset:45056
    ds_read_b64_tr_b16 a[26:27], v18 offset:46080
    s_add_u32 m0, s61, 134144
    s_add_u32 s66, s65, 98304
    buffer_load_dwordx4 v9, s[32:35], s66 offen sc1 lds
    s_waitcnt lgkmcnt(7)
    v_mfma_f32_32x32x16_bf16 v[112:127], a[12:15], a[32:35], v[112:127]
    ds_read_b64_tr_b16 a[28:29], v19 offset:45056
    ds_read_b64_tr_b16 a[30:31], v19 offset:46080
    s_waitcnt lgkmcnt(6)
    v_mfma_f32_32x32x16_bf16 v[64:79], a[16:19], a[36:39], v[64:79]
    s_waitcnt lgkmcnt(4)
    v_mfma_f32_32x32x16_bf16 v[80:95], a[20:23], a[36:39], v[80:95]
    s_waitcnt lgkmcnt(2)
    v_mfma_f32_32x32x16_bf16 v[96:111], a[24:27], a[36:39], v[96:111]
    s_waitcnt lgkmcnt(0)
    v_mfma_f32_32x32x16_bf16 v[112:127], a[28:31], a[36:39], v[112:127]
    s_waitcnt vmcnt(8)
    s_barrier
    ds_read_b128 a[32:35], v12 offset:0
    ds_read_b64_tr_b16 a[0:1], v16 offset:0
    ds_read_b64_tr_b16 a[2:3], v16 offset:1024
    ds_read_b64_tr_b16 a[4:5], v17 offset:0
    ds_read_b64_tr_b16 a[6:7], v17 offset:1024
    ds_read_b64_tr_b16 a[8:9], v18 offset:0
    ds_read_b64_tr_b16 a[10:11], v18 offset:1024
    ds_read_b64_tr_b16 a[12:13], v19 offset:0
    ds_read_b64_tr_b16 a[14:15], v19 offset:1024
    s_add_u32 s67, s49, 20480
    s_add_u32 m0, s57, 20480
    s_nop 0
    buffer_load_dwordx4 v4, s[24:27], s67 offen nt lds
    buffer_load_dwordx4 v5, s[24:27], s67 offen offset:1024 nt lds
    buffer_load_dwordx4 v6, s[24:27], s67 offen offset:2048 nt lds
    buffer_load_dwordx4 v7, s[24:27], s67 offen offset:3072 nt lds
    s_waitcnt lgkmcnt(6)
    v_mfma_f32_32x32x16_bf16 v[64:79], a[0:3], a[32:35], v[64:79]
    ds_read_b128 a[36:39], v13 offset:0
    ds_read_b64_tr_b16 a[16:17], v16 offset:4096
    ds_read_b64_tr_b16 a[18:19], v16 offset:5120
    s_add_u32 s67, s49, 49152
    buffer_load_dwordx4 a[128:131], v4, s[24:27], s67 offen nt
    s_waitcnt lgkmcnt(7)
    v_mfma_f32_32x32x16_bf16 v[80:95], a[4:7], a[32:35], v[80:95]
    ds_read_b64_tr_b16 a[20:21], v17 offset:4096
    ds_read_b64_tr_b16 a[22:23], v17 offset:5120
    buffer_load_dwordx4 a[132:135], v5, s[24:27], s67 offen offset:1024 nt
    s_waitcnt lgkmcnt(7)
    v_mfma_f32_32x32x16_bf16 v[96:111], a[8:11], a[32:35], v[96:111]
    ds_read_b64_tr_b16 a[24:25], v18 offset:4096
    ds_read_b64_tr_b16 a[26:27], v18 offset:5120
    buffer_load_dwordx4 a[136:139], v6, s[24:27], s67 offen offset:2048 nt
    s_waitcnt lgkmcnt(7)
    v_mfma_f32_32x32x16_bf16 v[112:127], a[12:15], a[32:35], v[112:127]
    ds_read_b64_tr_b16 a[28:29], v19 offset:4096
    ds_read_b64_tr_b16 a[30:31], v19 offset:5120
    s_add_u32 s63, s46, 8
    s_and_b32 s63, s63, 15
    s_lshl_b32 s64, s63, 7
    s_add_u32 s64, s64, s60
    s_lshl_b32 s65, s63, 19
    s_add_u32 s65, s65, s48
    s_add_u32 m0, s61, 65536
    s_nop 0
    buffer_load_dwordx4 v2, s[20:23], s64 offen sc1 lds
    s_waitcnt lgkmcnt(6)
    v_mfma_f32_32x32x16_bf16 v[64:79], a[16:19], a[36:39], v[64:79]
    ds_read_b128 a[32:35], v14 offset:0
    ds_read_b64_tr_b16 a[0:1], v16 offset:8192
    ds_read_b64_tr_b16 a[2:3], v16 offset:9216
    s_add_u32 m0, s61, 66560
    s_add_u32 s66, s64, 16384
    buffer_load_dwordx4 v3, s[20:23], s66 offen sc1 lds
    s_waitcnt lgkmcnt(7)
    v_mfma_f32_32x32x16_bf16 v[80:95], a[20:23], a[36:39], v[80:95]
    ds_read_b64_tr_b16 a[4:5], v17 offset:8192
    ds_read_b64_tr_b16 a[6:7], v17 offset:9216
    s_add_u32 m0, s61, 67584
    s_add_u32 s66, s64, 32768
    buffer_load_dwordx4 v2, s[20:23], s66 offen sc1 lds
    s_waitcnt lgkmcnt(7)
    v_mfma_f32_32x32x16_bf16 v[96:111], a[24:27], a[36:39], v[96:111]
    ds_read_b64_tr_b16 a[8:9], v18 offset:8192
    ds_read_b64_tr_b16 a[10:11], v18 offset:9216
    s_add_u32 m0, s61, 68608
    s_add_u32 s66, s64, 49152
    buffer_load_dwordx4 v3, s[20:23], s66 offen sc1 lds
    s_waitcnt lgkmcnt(7)
    v_mfma_f32_32x32x16_bf16 v[112:127], a[28:31], a[36:39], v[112:127]
    ds_read_b64_tr_b16 a[12:13], v19 offset:8192
    ds_read_b64_tr_b16 a[14:15], v19 offset:9216
    s_add_u32 m0, s61, 147456
    s_nop 0
    buffer_load_dwordx4 v9, s[32:35], s65 offen sc1 lds
    s_waitcnt lgkmcnt(6)
    v_mfma_f32_32x32x16_bf16 v[64:79], a[0:3], a[32:35], v[64:79]
    ds_read_b128 a[36:39], v15 offset:0
    ds_read_b64_tr_b16 a[16:17], v16 offset:12288
    ds_read_b64_tr_b16 a[18:19], v16 offset:13312
    s_add_u32 m0, s61, 148480
    s_add_u32 s66, s65, 32768
    buffer_load_dwordx4 v9, s[32:35], s66 offen sc1 lds
    s_waitcnt lgkmcnt(7)
    v_mfma_f32_32x32x16_bf16 v[80:95], a[4:7], a[32:35], v[80:95]
    ds_read_b64_tr_b16 a[20:21], v17 offset:12288
    ds_read_b64_tr_b16 a[22:23], v17 offset:13312
    s_add_u32 m0, s61, 149504
    s_add_u32 s66, s65, 65536
    buffer_load_dwordx4 v9, s[32:35], s66 offen sc1 lds
    s_waitcnt lgkmcnt(7)
    v_mfma_f32_32x32x16_bf16 v[96:111], a[8:11], a[32:35], v[96:111]
    ds_read_b64_tr_b16 a[24:25], v18 offset:12288
    ds_read_b64_tr_b16 a[26:27], v18 offset:13312
    s_add_u32 m0, s61, 150528
    s_add_u32 s66, s65, 98304
    buffer_load_dwordx4 v9, s[32:35], s66 offen sc1 lds
    s_waitcnt lgkmcnt(7)
    v_mfma_f32_32x32x16_bf16 v[112:127], a[12:15], a[32:35], v[112:127]
    ds_read_b64_tr_b16 a[28:29], v19 offset:12288
    ds_read_b64_tr_b16 a[30:31], v19 offset:13312
    s_waitcnt lgkmcnt(6)
    v_mfma_f32_32x32x16_bf16 v[64:79], a[16:19], a[36:39], v[64:79]
    s_waitcnt lgkmcnt(4)
    v_mfma_f32_32x32x16_bf16 v[80:95], a[20:23], a[36:39], v[80:95]
    s_waitcnt lgkmcnt(2)
    v_mfma_f32_32x32x16_bf16 v[96:111], a[24:27], a[36:39], v[96:111]
    s_waitcnt lgkmcnt(0)
    v_mfma_f32_32x32x16_bf16 v[112:127], a[28:31], a[36:39], v[112:127]
    s_waitcnt vmcnt(15)
    s_barrier
    ds_read_b128 a[32:35], v12 offset:16384
    ds_read_b64_tr_b16 a[0:1], v16 offset:16384
    ds_read_b64_tr_b16 a[2:3], v16 offset:17408
    ds_read_b64_tr_b16 a[4:5], v17 offset:16384
    ds_read_b64_tr_b16 a[6:7], v17 offset:17408
    ds_read_b64_tr_b16 a[8:9], v18 offset:16384
    ds_read_b64_tr_b16 a[10:11], v18 offset:17408
    ds_read_b64_tr_b16 a[12:13], v19 offset:16384
    ds_read_b64_tr_b16 a[14:15], v19 offset:17408
    s_add_u32 s63, s46, 9
    s_and_b32 s63, s63, 15
    s_lshl_b32 s64, s63, 7
    s_add_u32 s64, s64, s60
    s_lshl_b32 s65, s63, 19
    s_add_u32 s65, s65, s48
    s_add_u32 m0, s61, 32768
    s_nop 0
    buffer_load_dwordx4 v2, s[20:23], s64 offen sc1 lds
    s_add_u32 m0, s61, 33792
    s_add_u32 s66, s64, 16384
    buffer_load_dwordx4 v3, s[20:23], s66 offen sc1 lds
    s_waitcnt lgkmcnt(6)
    v_mfma_f32_32x32x16_bf16 v[64:79], a[0:3], a[32:35], v[64:79]
    ds_read_b128 a[36:39], v13 offset:16384
    ds_read_b64_tr_b16 a[16:17], v16 offset:20480
    ds_read_b64_tr_b16 a[18:19], v16 offset:21504
    s_add_u32 m0, s61, 34816
    s_add_u32 s66, s64, 32768
    buffer_load_dwordx4 v2, s[20:23], s66 offen sc1 lds
    s_waitcnt lgkmcnt(7)
    v_mfma_f32_32x32x16_bf16 v[80:95], a[4:7], a[32:35], v[80:95]
    ds_read_b64_tr_b16 a[20:21], v17 offset:20480
    ds_read_b64_tr_b16 a[22:23], v17 offset:21504
    s_waitcnt lgkmcnt(7)
    v_mfma_f32_32x32x16_bf16 v[96:111], a[8:11], a[32:35], v[96:111]
    ds_read_b64_tr_b16 a[24:25], v18 offset:20480
    ds_read_b64_tr_b16 a[26:27], v18 offset:21504
    s_add_u32 m0, s61, 35840
    s_add_u32 s66, s64, 49152
    buffer_load_dwordx4 v3, s[20:23], s66 offen sc1 lds
    s_waitcnt lgkmcnt(7)
    v_mfma_f32_32x32x16_bf16 v[112:127], a[12:15], a[32:35], v[112:127]
    ds_read_b64_tr_b16 a[28:29], v19 offset:20480
    ds_read_b64_tr_b16 a[30:31], v19 offset:21504
    s_waitcnt lgkmcnt(6)
    v_mfma_f32_32x32x16_bf16 v[64:79], a[16:19], a[36:39], v[64:79]
    ds_read_b128 a[32:35], v14 offset:16384
    ds_read_b64_tr_b16 a[0:1], v16 offset:24576
    ds_read_b64_tr_b16 a[2:3], v16 offset:25600
    s_add_u32 m0, s61, 114688
    s_nop 0
    buffer_load_dwordx4 v9, s[32:35], s65 offen sc1 lds
    s_waitcnt lgkmcnt(7)
    v_mfma_f32_32x32x16_bf16 v[80:95], a[20:23], a[36:39], v[80:95]
    ds_read_b64_tr_b16 a[4:5], v17 offset:24576
    ds_read_b64_tr_b16 a[6:7], v17 offset:25600
    s_waitcnt lgkmcnt(7)
    v_mfma_f32_32x32x16_bf16 v[96:111], a[24:27], a[36:39], v[96:111]
    ds_read_b64_tr_b16 a[8:9], v18 offset:24576
    ds_read_b64_tr_b16 a[10:11], v18 offset:25600
    s_add_u32 m0, s61, 115712
    s_add_u32 s66, s65, 32768
    buffer_load_dwordx4 v9, s[32:35], s66 offen sc1 lds
    s_waitcnt lgkmcnt(7)
    v_mfma_f32_32x32x16_bf16 v[112:127], a[28:31], a[36:39], v[112:127]
    ds_read_b64_tr_b16 a[12:13], v19 offset:24576
    ds_read_b64_tr_b16 a[14:15], v19 offset:25600
    s_waitcnt lgkmcnt(6)
    v_mfma_f32_32x32x16_bf16 v[64:79], a[0:3], a[32:35], v[64:79]
    ds_read_b128 a[36:39], v15 offset:16384
    ds_read_b64_tr_b16 a[16:17], v16 offset:28672
    ds_read_b64_tr_b16 a[18:19], v16 offset:29696
    s_add_u32 m0, s61, 116736
    s_add_u32 s66, s65, 65536
    buffer_load_dwordx4 v9, s[32:35], s66 offen sc1 lds
    s_waitcnt lgkmcnt(7)
    v_mfma_f32_32x32x16_bf16 v[80:95], a[4:7], a[32:35], v[80:95]
    ds_read_b64_tr_b16 a[20:21], v17 offset:28672
    ds_read_b64_tr_b16 a[22:23], v17 offset:29696
    s_waitcnt lgkmcnt(7)
    v_mfma_f32_32x32x16_bf16 v[96:111], a[8:11], a[32:35], v[96:111]
    ds_read_b64_tr_b16 a[24:25], v18 offset:28672
    ds_read_b64_tr_b16 a[26:27], v18 offset:29696
    s_add_u32 m0, s61, 117760
    s_add_u32 s66, s65, 98304
    buffer_load_dwordx4 v9, s[32:35], s66 offen sc1 lds
    s_waitcnt lgkmcnt(7)
    v_mfma_f32_32x32x16_bf16 v[112:127], a[12:15], a[32:35], v[112:127]
    ds_read_b64_tr_b16 a[28:29], v19 offset:28672
    ds_read_b64_tr_b16 a[30:31], v19 offset:29696
    s_waitcnt lgkmcnt(6)
    v_mfma_f32_32x32x16_bf16 v[64:79], a[16:19], a[36:39], v[64:79]
    s_waitcnt lgkmcnt(4)
    v_mfma_f32_32x32x16_bf16 v[80:95], a[20:23], a[36:39], v[80:95]
    s_waitcnt lgkmcnt(2)
    v_mfma_f32_32x32x16_bf16 v[96:111], a[24:27], a[36:39], v[96:111]
    s_waitcnt lgkmcnt(0)
    v_mfma_f32_32x32x16_bf16 v[112:127], a[28:31], a[36:39], v[112:127]
    s_waitcnt vmcnt(8)
    s_barrier
    ds_read_b128 a[32:35], v12 offset:32768
    ds_read_b64_tr_b16 a[0:1], v16 offset:32768
    ds_read_b64_tr_b16 a[2:3], v16 offset:33792
    ds_read_b64_tr_b16 a[4:5], v17 offset:32768
    ds_read_b64_tr_b16 a[6:7], v17 offset:33792
    ds_read_b64_tr_b16 a[8:9], v18 offset:32768
    ds_read_b64_tr_b16 a[10:11], v18 offset:33792
    ds_read_b64_tr_b16 a[12:13], v19 offset:32768
    ds_read_b64_tr_b16 a[14:15], v19 offset:33792
    buffer_load_dwordx4 a[140:143], v7, s[24:27], s67 offen offset:3072 nt
    s_add_u32 s67, s49, 53248
    buffer_load_dwordx4 a[144:147], v4, s[24:27], s67 offen nt
    buffer_load_dwordx4 a[148:151], v5, s[24:27], s67 offen offset:1024 nt
    buffer_load_dwordx4 a[152:155], v6, s[24:27], s67 offen offset:2048 nt
    s_waitcnt lgkmcnt(6)
    v_mfma_f32_32x32x16_bf16 v[64:79], a[0:3], a[32:35], v[64:79]
    ds_read_b128 a[36:39], v13 offset:32768
    ds_read_b64_tr_b16 a[16:17], v16 offset:36864
    ds_read_b64_tr_b16 a[18:19], v16 offset:37888
    buffer_load_dwordx4 a[156:159], v7, s[24:27], s67 offen offset:3072 nt
    s_waitcnt lgkmcnt(7)
    v_mfma_f32_32x32x16_bf16 v[80:95], a[4:7], a[32:35], v[80:95]
    ds_read_b64_tr_b16 a[20:21], v17 offset:36864
    ds_read_b64_tr_b16 a[22:23], v17 offset:37888
    s_add_u32 s67, s49, 32768
    buffer_load_dwordx4 a[160:163], v8, s[28:31], s67 offen nt
    s_waitcnt lgkmcnt(7)
    v_mfma_f32_32x32x16_bf16 v[96:111], a[8:11], a[32:35], v[96:111]
    ds_read_b64_tr_b16 a[24:25], v18 offset:36864
    ds_read_b64_tr_b16 a[26:27], v18 offset:37888
    buffer_load_dwordx4 a[164:167], v8, s[28:31], s67 offen offset:1024 nt
    s_waitcnt lgkmcnt(7)
    v_mfma_f32_32x32x16_bf16 v[112:127], a[12:15], a[32:35], v[112:127]
    ds_read_b64_tr_b16 a[28:29], v19 offset:36864
    ds_read_b64_tr_b16 a[30:31], v19 offset:37888
    s_add_u32 s63, s46, 10
    s_and_b32 s63, s63, 15
    s_lshl_b32 s64, s63, 7
    s_add_u32 s64, s64, s60
    s_lshl_b32 s65, s63, 19
    s_add_u32 s65, s65, s48
    s_add_u32 m0, s61, 49152
    s_nop 0
    buffer_load_dwordx4 v2, s[20:23], s64 offen sc1 lds
    s_waitcnt lgkmcnt(6)
    v_mfma_f32_32x32x16_bf16 v[64:79], a[16:19], a[36:39], v[64:79]
    ds_read_b128 a[32:35], v14 offset:32768
    ds_read_b64_tr_b16 a[0:1], v16 offset:40960
    ds_read_b64_tr_b16 a[2:3], v16 offset:41984
    s_add_u32 m0, s61, 50176
    s_add_u32 s66, s64, 16384
    buffer_load_dwordx4 v3, s[20:23], s66 offen sc1 lds
    s_waitcnt lgkmcnt(7)
    v_mfma_f32_32x32x16_bf16 v[80:95], a[20:23], a[36:39], v[80:95]
    ds_read_b64_tr_b16 a[4:5], v17 offset:40960
    ds_read_b64_tr_b16 a[6:7], v17 offset:41984
    s_add_u32 m0, s61, 51200
    s_add_u32 s66, s64, 32768
    buffer_load_dwordx4 v2, s[20:23], s66 offen sc1 lds
    s_waitcnt lgkmcnt(7)
    v_mfma_f32_32x32x16_bf16 v[96:111], a[24:27], a[36:39], v[96:111]
    ds_read_b64_tr_b16 a[8:9], v18 offset:40960
    ds_read_b64_tr_b16 a[10:11], v18 offset:41984
    s_add_u32 m0, s61, 52224
    s_add_u32 s66, s64, 49152
    buffer_load_dwordx4 v3, s[20:23], s66 offen sc1 lds
    s_waitcnt lgkmcnt(7)
    v_mfma_f32_32x32x16_bf16 v[112:127], a[28:31], a[36:39], v[112:127]
    ds_read_b64_tr_b16 a[12:13], v19 offset:40960
    ds_read_b64_tr_b16 a[14:15], v19 offset:41984
    s_add_u32 m0, s61, 131072
    s_nop 0
    buffer_load_dwordx4 v9, s[32:35], s65 offen sc1 lds
    s_waitcnt lgkmcnt(6)
    v_mfma_f32_32x32x16_bf16 v[64:79], a[0:3], a[32:35], v[64:79]
    ds_read_b128 a[36:39], v15 offset:32768
    ds_read_b64_tr_b16 a[16:17], v16 offset:45056
    ds_read_b64_tr_b16 a[18:19], v16 offset:46080
    s_add_u32 m0, s61, 132096
    s_add_u32 s66, s65, 32768
    buffer_load_dwordx4 v9, s[32:35], s66 offen sc1 lds
    s_waitcnt lgkmcnt(7)
    v_mfma_f32_32x32x16_bf16 v[80:95], a[4:7], a[32:35], v[80:95]
    ds_read_b64_tr_b16 a[20:21], v17 offset:45056
    ds_read_b64_tr_b16 a[22:23], v17 offset:46080
    s_add_u32 m0, s61, 133120
    s_add_u32 s66, s65, 65536
    buffer_load_dwordx4 v9, s[32:35], s66 offen sc1 lds
    s_waitcnt lgkmcnt(7)
    v_mfma_f32_32x32x16_bf16 v[96:111], a[8:11], a[32:35], v[96:111]
    ds_read_b64_tr_b16 a[24:25], v18 offset:45056
    ds_read_b64_tr_b16 a[26:27], v18 offset:46080
    s_add_u32 m0, s61, 134144
    s_add_u32 s66, s65, 98304
    buffer_load_dwordx4 v9, s[32:35], s66 offen sc1 lds
    s_waitcnt lgkmcnt(7)
    v_mfma_f32_32x32x16_bf16 v[112:127], a[12:15], a[32:35], v[112:127]
    ds_read_b64_tr_b16 a[28:29], v19 offset:45056
    ds_read_b64_tr_b16 a[30:31], v19 offset:46080
    s_waitcnt lgkmcnt(6)
    v_mfma_f32_32x32x16_bf16 v[64:79], a[16:19], a[36:39], v[64:79]
    s_waitcnt lgkmcnt(4)
    v_mfma_f32_32x32x16_bf16 v[80:95], a[20:23], a[36:39], v[80:95]
    s_waitcnt lgkmcnt(2)
    v_mfma_f32_32x32x16_bf16 v[96:111], a[24:27], a[36:39], v[96:111]
    s_waitcnt lgkmcnt(0)
    v_mfma_f32_32x32x16_bf16 v[112:127], a[28:31], a[36:39], v[112:127]
    s_waitcnt vmcnt(15)
    s_barrier
    ds_read_b128 a[32:35], v12 offset:0
    ds_read_b64_tr_b16 a[0:1], v16 offset:0
    ds_read_b64_tr_b16 a[2:3], v16 offset:1024
    ds_read_b64_tr_b16 a[4:5], v17 offset:0
    ds_read_b64_tr_b16 a[6:7], v17 offset:1024
    ds_read_b64_tr_b16 a[8:9], v18 offset:0
    ds_read_b64_tr_b16 a[10:11], v18 offset:1024
    ds_read_b64_tr_b16 a[12:13], v19 offset:0
    ds_read_b64_tr_b16 a[14:15], v19 offset:1024
    s_add_u32 s63, s46, 11
    s_and_b32 s63, s63, 15
    s_lshl_b32 s64, s63, 7
    s_add_u32 s64, s64, s60
    s_lshl_b32 s65, s63, 19
    s_add_u32 s65, s65, s48
    s_add_u32 m0, s61, 65536
    s_nop 0
    buffer_load_dwordx4 v2, s[20:23], s64 offen sc1 lds
    s_add_u32 m0, s61, 66560
    s_add_u32 s66, s64, 16384
    buffer_load_dwordx4 v3, s[20:23], s66 offen sc1 lds
    s_waitcnt lgkmcnt(6)
    v_mfma_f32_32x32x16_bf16 v[64:79], a[0:3], a[32:35], v[64:79]
    ds_read_b128 a[36:39], v13 offset:0
    ds_read_b64_tr_b16 a[16:17], v16 offset:4096
    ds_read_b64_tr_b16 a[18:19], v16 offset:5120
    s_add_u32 m0, s61, 67584
    s_add_u32 s66, s64, 32768
    buffer_load_dwordx4 v2, s[20:23], s66 offen sc1 lds
    s_waitcnt lgkmcnt(7)
    v_mfma_f32_32x32x16_bf16 v[80:95], a[4:7], a[32:35], v[80:95]
    ds_read_b64_tr_b16 a[20:21], v17 offset:4096
    ds_read_b64_tr_b16 a[22:23], v17 offset:5120
    s_waitcnt lgkmcnt(7)
    v_mfma_f32_32x32x16_bf16 v[96:111], a[8:11], a[32:35], v[96:111]
    ds_read_b64_tr_b16 a[24:25], v18 offset:4096
    ds_read_b64_tr_b16 a[26:27], v18 offset:5120
    s_add_u32 m0, s61, 68608
    s_add_u32 s66, s64, 49152
    buffer_load_dwordx4 v3, s[20:23], s66 offen sc1 lds
    s_waitcnt lgkmcnt(7)
    v_mfma_f32_32x32x16_bf16 v[112:127], a[12:15], a[32:35], v[112:127]
    ds_read_b64_tr_b16 a[28:29], v19 offset:4096
    ds_read_b64_tr_b16 a[30:31], v19 offset:5120
    s_waitcnt lgkmcnt(6)
    v_mfma_f32_32x32x16_bf16 v[64:79], a[16:19], a[36:39], v[64:79]
    ds_read_b128 a[32:35], v14 offset:0
    ds_read_b64_tr_b16 a[0:1], v16 offset:8192
    ds_read_b64_tr_b16 a[2:3], v16 offset:9216
    s_add_u32 m0, s61, 147456
    s_nop 0
    buffer_load_dwordx4 v9, s[32:35], s65 offen sc1 lds
    s_waitcnt lgkmcnt(7)
    v_mfma_f32_32x32x16_bf16 v[80:95], a[20:23], a[36:39], v[80:95]
    ds_read_b64_tr_b16 a[4:5], v17 offset:8192
    ds_read_b64_tr_b16 a[6:7], v17 offset:9216
    s_waitcnt lgkmcnt(7)
    v_mfma_f32_32x32x16_bf16 v[96:111], a[24:27], a[36:39], v[96:111]
    ds_read_b64_tr_b16 a[8:9], v18 offset:8192
    ds_read_b64_tr_b16 a[10:11], v18 offset:9216
    s_add_u32 m0, s61, 148480
    s_add_u32 s66, s65, 32768
    buffer_load_dwordx4 v9, s[32:35], s66 offen sc1 lds
    s_waitcnt lgkmcnt(7)
    v_mfma_f32_32x32x16_bf16 v[112:127], a[28:31], a[36:39], v[112:127]
    ds_read_b64_tr_b16 a[12:13], v19 offset:8192
    ds_read_b64_tr_b16 a[14:15], v19 offset:9216
    s_waitcnt lgkmcnt(6)
    v_mfma_f32_32x32x16_bf16 v[64:79], a[0:3], a[32:35], v[64:79]
    ds_read_b128 a[36:39], v15 offset:0
    ds_read_b64_tr_b16 a[16:17], v16 offset:12288
    ds_read_b64_tr_b16 a[18:19], v16 offset:13312
    s_add_u32 m0, s61, 149504
    s_add_u32 s66, s65, 65536
    buffer_load_dwordx4 v9, s[32:35], s66 offen sc1 lds
    s_waitcnt lgkmcnt(7)
    v_mfma_f32_32x32x16_bf16 v[80:95], a[4:7], a[32:35], v[80:95]
    ds_read_b64_tr_b16 a[20:21], v17 offset:12288
    ds_read_b64_tr_b16 a[22:23], v17 offset:13312
    s_waitcnt lgkmcnt(7)
    v_mfma_f32_32x32x16_bf16 v[96:111], a[8:11], a[32:35], v[96:111]
    ds_read_b64_tr_b16 a[24:25], v18 offset:12288
    ds_read_b64_tr_b16 a[26:27], v18 offset:13312
    s_add_u32 m0, s61, 150528
    s_add_u32 s66, s65, 98304
    buffer_load_dwordx4 v9, s[32:35], s66 offen sc1 lds
    s_waitcnt lgkmcnt(7)
    v_mfma_f32_32x32x16_bf16 v[112:127], a[12:15], a[32:35], v[112:127]
    ds_read_b64_tr_b16 a[28:29], v19 offset:12288
    ds_read_b64_tr_b16 a[30:31], v19 offset:13312
    s_waitcnt lgkmcnt(6)
    v_mfma_f32_32x32x16_bf16 v[64:79], a[16:19], a[36:39], v[64:79]
    s_waitcnt lgkmcnt(4)
    v_mfma_f32_32x32x16_bf16 v[80:95], a[20:23], a[36:39], v[80:95]
    s_waitcnt lgkmcnt(2)
    v_mfma_f32_32x32x16_bf16 v[96:111], a[24:27], a[36:39], v[96:111]
    s_waitcnt lgkmcnt(0)
    v_mfma_f32_32x32x16_bf16 v[112:127], a[28:31], a[36:39], v[112:127]
    s_waitcnt vmcnt(8)
    s_barrier
    ds_read_b128 a[32:35], v12 offset:16384
    ds_read_b64_tr_b16 a[0:1], v16 offset:16384
    ds_read_b64_tr_b16 a[2:3], v16 offset:17408
    ds_read_b64_tr_b16 a[4:5], v17 offset:16384
    ds_read_b64_tr_b16 a[6:7], v17 offset:17408
    ds_read_b64_tr_b16 a[8:9], v18 offset:16384
    ds_read_b64_tr_b16 a[10:11], v18 offset:17408
    ds_read_b64_tr_b16 a[12:13], v19 offset:16384
    ds_read_b64_tr_b16 a[14:15], v19 offset:17408
    buffer_load_dwordx4 a[168:171], v8, s[28:31], s67 offen offset:2048 nt
    buffer_load_dwordx4 a[172:175], v8, s[28:31], s67 offen offset:3072 nt
    s_add_u32 s67, s49, 36864
    buffer_load_dwordx4 a[176:179], v8, s[28:31], s67 offen nt
    buffer_load_dwordx4 a[180:183], v8, s[28:31], s67 offen offset:1024 nt
    s_waitcnt lgkmcnt(6)
    v_mfma_f32_32x32x16_bf16 v[64:79], a[0:3], a[32:35], v[64:79]
    ds_read_b128 a[36:39], v13 offset:16384
    ds_read_b64_tr_b16 a[16:17], v16 offset:20480
    ds_read_b64_tr_b16 a[18:19], v16 offset:21504
    buffer_load_dwordx4 a[184:187], v8, s[28:31], s67 offen offset:2048 nt
    s_waitcnt lgkmcnt(7)
    v_mfma_f32_32x32x16_bf16 v[80:95], a[4:7], a[32:35], v[80:95]
    ds_read_b64_tr_b16 a[20:21], v17 offset:20480
    ds_read_b64_tr_b16 a[22:23], v17 offset:21504
    buffer_load_dwordx4 a[188:191], v8, s[28:31], s67 offen offset:3072 nt
    s_waitcnt lgkmcnt(7)
    v_mfma_f32_32x32x16_bf16 v[96:111], a[8:11], a[32:35], v[96:111]
    ds_read_b64_tr_b16 a[24:25], v18 offset:20480
    ds_read_b64_tr_b16 a[26:27], v18 offset:21504
    s_add_u32 s67, s49, 0
    buffer_load_dwordx4 v[160:163], v8, s[28:31], s67 offen nt
    s_waitcnt lgkmcnt(7)
    v_mfma_f32_32x32x16_bf16 v[112:127], a[12:15], a[32:35], v[112:127]
    ds_read_b64_tr_b16 a[28:29], v19 offset:20480
    ds_read_b64_tr_b16 a[30:31], v19 offset:21504
    s_add_u32 s63, s46, 12
    s_and_b32 s63, s63, 15
    s_lshl_b32 s64, s63, 7
    s_add_u32 s64, s64, s60
    s_lshl_b32 s65, s63, 19
    s_add_u32 s65, s65, s48
    s_add_u32 m0, s61, 32768
    s_nop 0
    buffer_load_dwordx4 v2, s[20:23], s64 offen sc1 lds
    s_waitcnt lgkmcnt(6)
    v_mfma_f32_32x32x16_bf16 v[64:79], a[16:19], a[36:39], v[64:79]
    ds_read_b128 a[32:35], v14 offset:16384
    ds_read_b64_tr_b16 a[0:1], v16 offset:24576
    ds_read_b64_tr_b16 a[2:3], v16 offset:25600
    s_add_u32 m0, s61, 33792
    s_add_u32 s66, s64, 16384
    buffer_load_dwordx4 v3, s[20:23], s66 offen sc1 lds
    s_waitcnt lgkmcnt(7)
    v_mfma_f32_32x32x16_bf16 v[80:95], a[20:23], a[36:39], v[80:95]
    ds_read_b64_tr_b16 a[4:5], v17 offset:24576
    ds_read_b64_tr_b16 a[6:7], v17 offset:25600
    s_add_u32 m0, s61, 34816
    s_add_u32 s66, s64, 32768
    buffer_load_dwordx4 v2, s[20:23], s66 offen sc1 lds
    s_waitcnt lgkmcnt(7)
    v_mfma_f32_32x32x16_bf16 v[96:111], a[24:27], a[36:39], v[96:111]
    ds_read_b64_tr_b16 a[8:9], v18 offset:24576
    ds_read_b64_tr_b16 a[10:11], v18 offset:25600
    s_add_u32 m0, s61, 35840
    s_add_u32 s66, s64, 49152
    buffer_load_dwordx4 v3, s[20:23], s66 offen sc1 lds
    s_waitcnt lgkmcnt(7)
    v_mfma_f32_32x32x16_bf16 v[112:127], a[28:31], a[36:39], v[112:127]
    ds_read_b64_tr_b16 a[12:13], v19 offset:24576
    ds_read_b64_tr_b16 a[14:15], v19 offset:25600
    s_add_u32 m0, s61, 114688
    s_nop 0
    buffer_load_dwordx4 v9, s[32:35], s65 offen sc1 lds
    s_waitcnt lgkmcnt(6)
    v_mfma_f32_32x32x16_bf16 v[64:79], a[0:3], a[32:35], v[64:79]
    ds_read_b128 a[36:39], v15 offset:16384
    ds_read_b64_tr_b16 a[16:17], v16 offset:28672
    ds_read_b64_tr_b16 a[18:19], v16 offset:29696
    s_add_u32 m0, s61, 115712
    s_add_u32 s66, s65, 32768
    buffer_load_dwordx4 v9, s[32:35], s66 offen sc1 lds
    s_waitcnt lgkmcnt(7)
    v_mfma_f32_32x32x16_bf16 v[80:95], a[4:7], a[32:35], v[80:95]
    ds_read_b64_tr_b16 a[20:21], v17 offset:28672
    ds_read_b64_tr_b16 a[22:23], v17 offset:29696
    s_add_u32 m0, s61, 116736
    s_add_u32 s66, s65, 65536
    buffer_load_dwordx4 v9, s[32:35], s66 offen sc1 lds
    s_waitcnt lgkmcnt(7)
    v_mfma_f32_32x32x16_bf16 v[96:111], a[8:11], a[32:35], v[96:111]
    ds_read_b64_tr_b16 a[24:25], v18 offset:28672
    ds_read_b64_tr_b16 a[26:27], v18 offset:29696
    s_add_u32 m0, s61, 117760
    s_add_u32 s66, s65, 98304
    buffer_load_dwordx4 v9, s[32:35], s66 offen sc1 lds
    s_waitcnt lgkmcnt(7)
    v_mfma_f32_32x32x16_bf16 v[112:127], a[12:15], a[32:35], v[112:127]
    ds_read_b64_tr_b16 a[28:29], v19 offset:28672
    ds_read_b64_tr_b16 a[30:31], v19 offset:29696
    s_waitcnt lgkmcnt(6)
    v_mfma_f32_32x32x16_bf16 v[64:79], a[16:19], a[36:39], v[64:79]
    s_waitcnt lgkmcnt(4)
    v_mfma_f32_32x32x16_bf16 v[80:95], a[20:23], a[36:39], v[80:95]
    s_waitcnt lgkmcnt(2)
    v_mfma_f32_32x32x16_bf16 v[96:111], a[24:27], a[36:39], v[96:111]
    s_waitcnt lgkmcnt(0)
    v_mfma_f32_32x32x16_bf16 v[112:127], a[28:31], a[36:39], v[112:127]
    s_waitcnt vmcnt(15)
    s_barrier
    ds_read_b128 a[32:35], v12 offset:32768
    ds_read_b64_tr_b16 a[0:1], v16 offset:32768
    ds_read_b64_tr_b16 a[2:3], v16 offset:33792
    ds_read_b64_tr_b16 a[4:5], v17 offset:32768
    ds_read_b64_tr_b16 a[6:7], v17 offset:33792
    ds_read_b64_tr_b16 a[8:9], v18 offset:32768
    ds_read_b64_tr_b16 a[10:11], v18 offset:33792
    ds_read_b64_tr_b16 a[12:13], v19 offset:32768
    ds_read_b64_tr_b16 a[14:15], v19 offset:33792
    s_add_u32 s63, s46, 13
    s_and_b32 s63, s63, 15
    s_lshl_b32 s64, s63, 7
    s_add_u32 s64, s64, s60
    s_lshl_b32 s65, s63, 19
    s_add_u32 s65, s65, s48
    s_add_u32 m0, s61, 49152
    s_nop 0
    buffer_load_dwordx4 v2, s[20:23], s64 offen sc1 lds
    s_add_u32 m0, s61, 50176
    s_add_u32 s66, s64, 16384
    buffer_load_dwordx4 v3, s[20:23], s66 offen sc1 lds
    s_waitcnt lgkmcnt(6)
    v_mfma_f32_32x32x16_bf16 v[64:79], a[0:3], a[32:35], v[64:79]
    ds_read_b128 a[36:39], v13 offset:32768
    ds_read_b64_tr_b16 a[16:17], v16 offset:36864
    ds_read_b64_tr_b16 a[18:19], v16 offset:37888
    s_add_u32 m0, s61, 51200
    s_add_u32 s66, s64, 32768
    buffer_load_dwordx4 v2, s[20:23], s66 offen sc1 lds
    s_waitcnt lgkmcnt(7)
    v_mfma_f32_32x32x16_bf16 v[80:95], a[4:7], a[32:35], v[80:95]
    ds_read_b64_tr_b16 a[20:21], v17 offset:36864
    ds_read_b64_tr_b16 a[22:23], v17 offset:37888
    s_waitcnt lgkmcnt(7)
    v_mfma_f32_32x32x16_bf16 v[96:111], a[8:11], a[32:35], v[96:111]
    ds_read_b64_tr_b16 a[24:25], v18 offset:36864
    ds_read_b64_tr_b16 a[26:27], v18 offset:37888
    s_add_u32 m0, s61, 52224
    s_add_u32 s66, s64, 49152
    buffer_load_dwordx4 v3, s[20:23], s66 offen sc1 lds
    s_waitcnt lgkmcnt(7)
    v_mfma_f32_32x32x16_bf16 v[112:127], a[12:15], a[32:35], v[112:127]
    ds_read_b64_tr_b16 a[28:29], v19 offset:36864
    ds_read_b64_tr_b16 a[30:31], v19 offset:37888
    s_waitcnt lgkmcnt(6)
    v_mfma_f32_32x32x16_bf16 v[64:79], a[16:19], a[36:39], v[64:79]
    ds_read_b128 a[32:35], v14 offset:32768
    ds_read_b64_tr_b16 a[0:1], v16 offset:40960
    ds_read_b64_tr_b16 a[2:3], v16 offset:41984
    s_add_u32 m0, s61, 131072
    s_nop 0
    buffer_load_dwordx4 v9, s[32:35], s65 offen sc1 lds
    s_waitcnt lgkmcnt(7)
    v_mfma_f32_32x32x16_bf16 v[80:95], a[20:23], a[36:39], v[80:95]
    ds_read_b64_tr_b16 a[4:5], v17 offset:40960
    ds_read_b64_tr_b16 a[6:7], v17 offset:41984
    s_waitcnt lgkmcnt(7)
    v_mfma_f32_32x32x16_bf16 v[96:111], a[24:27], a[36:39], v[96:111]
    ds_read_b64_tr_b16 a[8:9], v18 offset:40960
    ds_read_b64_tr_b16 a[10:11], v18 offset:41984
    s_add_u32 m0, s61, 132096
    s_add_u32 s66, s65, 32768
    buffer_load_dwordx4 v9, s[32:35], s66 offen sc1 lds
    s_waitcnt lgkmcnt(7)
    v_mfma_f32_32x32x16_bf16 v[112:127], a[28:31], a[36:39], v[112:127]
    ds_read_b64_tr_b16 a[12:13], v19 offset:40960
    ds_read_b64_tr_b16 a[14:15], v19 offset:41984
    s_waitcnt lgkmcnt(6)
    v_mfma_f32_32x32x16_bf16 v[64:79], a[0:3], a[32:35], v[64:79]
    ds_read_b128 a[36:39], v15 offset:32768
    ds_read_b64_tr_b16 a[16:17], v16 offset:45056
    ds_read_b64_tr_b16 a[18:19], v16 offset:46080
    s_add_u32 m0, s61, 133120
    s_add_u32 s66, s65, 65536
    buffer_load_dwordx4 v9, s[32:35], s66 offen sc1 lds
    s_waitcnt lgkmcnt(7)
    v_mfma_f32_32x32x16_bf16 v[80:95], a[4:7], a[32:35], v[80:95]
    ds_read_b64_tr_b16 a[20:21], v17 offset:45056
    ds_read_b64_tr_b16 a[22:23], v17 offset:46080
    s_waitcnt lgkmcnt(7)
    v_mfma_f32_32x32x16_bf16 v[96:111], a[8:11], a[32:35], v[96:111]
    ds_read_b64_tr_b16 a[24:25], v18 offset:45056
    ds_read_b64_tr_b16 a[26:27], v18 offset:46080
    s_add_u32 m0, s61, 134144
    s_add_u32 s66, s65, 98304
    buffer_load_dwordx4 v9, s[32:35], s66 offen sc1 lds
    s_waitcnt lgkmcnt(7)
    v_mfma_f32_32x32x16_bf16 v[112:127], a[12:15], a[32:35], v[112:127]
    ds_read_b64_tr_b16 a[28:29], v19 offset:45056
    ds_read_b64_tr_b16 a[30:31], v19 offset:46080
    s_waitcnt lgkmcnt(6)
    v_mfma_f32_32x32x16_bf16 v[64:79], a[16:19], a[36:39], v[64:79]
    s_waitcnt lgkmcnt(4)
    v_mfma_f32_32x32x16_bf16 v[80:95], a[20:23], a[36:39], v[80:95]
    s_waitcnt lgkmcnt(2)
    v_mfma_f32_32x32x16_bf16 v[96:111], a[24:27], a[36:39], v[96:111]
    s_waitcnt lgkmcnt(0)
    v_mfma_f32_32x32x16_bf16 v[112:127], a[28:31], a[36:39], v[112:127]
    s_waitcnt vmcnt(8)
    s_barrier
    ds_read_b128 a[32:35], v12 offset:0
    ds_read_b64_tr_b16 a[0:1], v16 offset:0
    ds_read_b64_tr_b16 a[2:3], v16 offset:1024
    ds_read_b64_tr_b16 a[4:5], v17 offset:0
    ds_read_b64_tr_b16 a[6:7], v17 offset:1024
    ds_read_b64_tr_b16 a[8:9], v18 offset:0
    ds_read_b64_tr_b16 a[10:11], v18 offset:1024
    ds_read_b64_tr_b16 a[12:13], v19 offset:0
    ds_read_b64_tr_b16 a[14:15], v19 offset:1024
    buffer_load_dwordx4 v[164:167], v8, s[28:31], s67 offen offset:1024 nt
    buffer_load_dwordx4 v[168:171], v8, s[28:31], s67 offen offset:2048 nt
    buffer_load_dwordx4 v[172:175], v8, s[28:31], s67 offen offset:3072 nt
    s_add_u32 s67, s49, 4096
    buffer_load_dwordx4 v[176:179], v8, s[28:31], s67 offen nt
    s_waitcnt lgkmcnt(6)
    v_mfma_f32_32x32x16_bf16 v[64:79], a[0:3], a[32:35], v[64:79]
    ds_read_b128 a[36:39], v13 offset:0
    ds_read_b64_tr_b16 a[16:17], v16 offset:4096
    ds_read_b64_tr_b16 a[18:19], v16 offset:5120
    buffer_load_dwordx4 v[180:183], v8, s[28:31], s67 offen offset:1024 nt
    s_waitcnt lgkmcnt(7)
    v_mfma_f32_32x32x16_bf16 v[80:95], a[4:7], a[32:35], v[80:95]
    ds_read_b64_tr_b16 a[20:21], v17 offset:4096
    ds_read_b64_tr_b16 a[22:23], v17 offset:5120
    buffer_load_dwordx4 v[184:187], v8, s[28:31], s67 offen offset:2048 nt
    s_waitcnt lgkmcnt(7)
    v_mfma_f32_32x32x16_bf16 v[96:111], a[8:11], a[32:35], v[96:111]
    ds_read_b64_tr_b16 a[24:25], v18 offset:4096
    ds_read_b64_tr_b16 a[26:27], v18 offset:5120
    buffer_load_dwordx4 v[188:191], v8, s[28:31], s67 offen offset:3072 nt
    s_waitcnt lgkmcnt(7)
    v_mfma_f32_32x32x16_bf16 v[112:127], a[12:15], a[32:35], v[112:127]
    ds_read_b64_tr_b16 a[28:29], v19 offset:4096
    ds_read_b64_tr_b16 a[30:31], v19 offset:5120
    s_add_u32 s63, s46, 14
    s_and_b32 s63, s63, 15
    s_lshl_b32 s64, s63, 7
    s_add_u32 s64, s64, s60
    s_lshl_b32 s65, s63, 19
    s_add_u32 s65, s65, s48
    s_add_u32 m0, s61, 65536
    s_nop 0
    buffer_load_dwordx4 v2, s[20:23], s64 offen sc1 lds
    s_waitcnt lgkmcnt(6)
    v_mfma_f32_32x32x16_bf16 v[64:79], a[16:19], a[36:39], v[64:79]
    ds_read_b128 a[32:35], v14 offset:0
    ds_read_b64_tr_b16 a[0:1], v16 offset:8192
    ds_read_b64_tr_b16 a[2:3], v16 offset:9216
    s_add_u32 m0, s61, 66560
    s_add_u32 s66, s64, 16384
    buffer_load_dwordx4 v3, s[20:23], s66 offen sc1 lds
    s_waitcnt lgkmcnt(7)
    v_mfma_f32_32x32x16_bf16 v[80:95], a[20:23], a[36:39], v[80:95]
    ds_read_b64_tr_b16 a[4:5], v17 offset:8192
    ds_read_b64_tr_b16 a[6:7], v17 offset:9216
    s_add_u32 m0, s61, 67584
    s_add_u32 s66, s64, 32768
    buffer_load_dwordx4 v2, s[20:23], s66 offen sc1 lds
    s_waitcnt lgkmcnt(7)
    v_mfma_f32_32x32x16_bf16 v[96:111], a[24:27], a[36:39], v[96:111]
    ds_read_b64_tr_b16 a[8:9], v18 offset:8192
    ds_read_b64_tr_b16 a[10:11], v18 offset:9216
    s_add_u32 m0, s61, 68608
    s_add_u32 s66, s64, 49152
    buffer_load_dwordx4 v3, s[20:23], s66 offen sc1 lds
    s_waitcnt lgkmcnt(7)
    v_mfma_f32_32x32x16_bf16 v[112:127], a[28:31], a[36:39], v[112:127]
    ds_read_b64_tr_b16 a[12:13], v19 offset:8192
    ds_read_b64_tr_b16 a[14:15], v19 offset:9216
    s_add_u32 m0, s61, 147456
    s_nop 0
    buffer_load_dwordx4 v9, s[32:35], s65 offen sc1 lds
    s_waitcnt lgkmcnt(6)
    v_mfma_f32_32x32x16_bf16 v[64:79], a[0:3], a[32:35], v[64:79]
    ds_read_b128 a[36:39], v15 offset:0
    ds_read_b64_tr_b16 a[16:17], v16 offset:12288
    ds_read_b64_tr_b16 a[18:19], v16 offset:13312
    s_add_u32 m0, s61, 148480
    s_add_u32 s66, s65, 32768
    buffer_load_dwordx4 v9, s[32:35], s66 offen sc1 lds
    s_waitcnt lgkmcnt(7)
    v_mfma_f32_32x32x16_bf16 v[80:95], a[4:7], a[32:35], v[80:95]
    ds_read_b64_tr_b16 a[20:21], v17 offset:12288
    ds_read_b64_tr_b16 a[22:23], v17 offset:13312
    s_add_u32 m0, s61, 149504
    s_add_u32 s66, s65, 65536
    buffer_load_dwordx4 v9, s[32:35], s66 offen sc1 lds
    s_waitcnt lgkmcnt(7)
    v_mfma_f32_32x32x16_bf16 v[96:111], a[8:11], a[32:35], v[96:111]
    ds_read_b64_tr_b16 a[24:25], v18 offset:12288
    ds_read_b64_tr_b16 a[26:27], v18 offset:13312
    s_add_u32 m0, s61, 150528
    s_add_u32 s66, s65, 98304
    buffer_load_dwordx4 v9, s[32:35], s66 offen sc1 lds
    s_waitcnt lgkmcnt(7)
    v_mfma_f32_32x32x16_bf16 v[112:127], a[12:15], a[32:35], v[112:127]
    ds_read_b64_tr_b16 a[28:29], v19 offset:12288
    ds_read_b64_tr_b16 a[30:31], v19 offset:13312
    s_waitcnt lgkmcnt(6)
    v_mfma_f32_32x32x16_bf16 v[64:79], a[16:19], a[36:39], v[64:79]
    s_waitcnt lgkmcnt(4)
    v_mfma_f32_32x32x16_bf16 v[80:95], a[20:23], a[36:39], v[80:95]
    s_waitcnt lgkmcnt(2)
    v_mfma_f32_32x32x16_bf16 v[96:111], a[24:27], a[36:39], v[96:111]
    s_waitcnt lgkmcnt(0)
    v_mfma_f32_32x32x16_bf16 v[112:127], a[28:31], a[36:39], v[112:127]
    s_waitcnt vmcnt(15)
    s_barrier
    ds_read_b128 a[32:35], v12 offset:16384
    ds_read_b64_tr_b16 a[0:1], v16 offset:16384
    ds_read_b64_tr_b16 a[2:3], v16 offset:17408
    ds_read_b64_tr_b16 a[4:5], v17 offset:16384
    ds_read_b64_tr_b16 a[6:7], v17 offset:17408
    ds_read_b64_tr_b16 a[8:9], v18 offset:16384
    ds_read_b64_tr_b16 a[10:11], v18 offset:17408
    ds_read_b64_tr_b16 a[12:13], v19 offset:16384
    ds_read_b64_tr_b16 a[14:15], v19 offset:17408
    s_add_u32 s63, s46, 15
    s_and_b32 s63, s63, 15
    s_lshl_b32 s64, s63, 7
    s_add_u32 s64, s64, s60
    s_lshl_b32 s65, s63, 19
    s_add_u32 s65, s65, s48
    s_add_u32 m0, s61, 32768
    s_nop 0
    buffer_load_dwordx4 v2, s[20:23], s64 offen sc1 lds
    s_add_u32 m0, s61, 33792
    s_add_u32 s66, s64, 16384
    buffer_load_dwordx4 v3, s[20:23], s66 offen sc1 lds
    s_waitcnt lgkmcnt(6)
    v_mfma_f32_32x32x16_bf16 v[64:79], a[0:3], a[32:35], v[64:79]
    ds_read_b128 a[36:39], v13 offset:16384
    ds_read_b64_tr_b16 a[16:17], v16 offset:20480
    ds_read_b64_tr_b16 a[18:19], v16 offset:21504
    s_add_u32 m0, s61, 34816
    s_add_u32 s66, s64, 32768
    buffer_load_dwordx4 v2, s[20:23], s66 offen sc1 lds
    s_waitcnt lgkmcnt(7)
    v_mfma_f32_32x32x16_bf16 v[80:95], a[4:7], a[32:35], v[80:95]
    ds_read_b64_tr_b16 a[20:21], v17 offset:20480
    ds_read_b64_tr_b16 a[22:23], v17 offset:21504
    s_waitcnt lgkmcnt(7)
    v_mfma_f32_32x32x16_bf16 v[96:111], a[8:11], a[32:35], v[96:111]
    ds_read_b64_tr_b16 a[24:25], v18 offset:20480
    ds_read_b64_tr_b16 a[26:27], v18 offset:21504
    s_add_u32 m0, s61, 35840
    s_add_u32 s66, s64, 49152
    buffer_load_dwordx4 v3, s[20:23], s66 offen sc1 lds
    s_waitcnt lgkmcnt(7)
    v_mfma_f32_32x32x16_bf16 v[112:127], a[12:15], a[32:35], v[112:127]
    ds_read_b64_tr_b16 a[28:29], v19 offset:20480
    ds_read_b64_tr_b16 a[30:31], v19 offset:21504
    s_waitcnt lgkmcnt(6)
    v_mfma_f32_32x32x16_bf16 v[64:79], a[16:19], a[36:39], v[64:79]
    ds_read_b128 a[32:35], v14 offset:16384
    ds_read_b64_tr_b16 a[0:1], v16 offset:24576
    ds_read_b64_tr_b16 a[2:3], v16 offset:25600
    s_add_u32 m0, s61, 114688
    s_nop 0
    buffer_load_dwordx4 v9, s[32:35], s65 offen sc1 lds
    s_waitcnt lgkmcnt(7)
    v_mfma_f32_32x32x16_bf16 v[80:95], a[20:23], a[36:39], v[80:95]
    ds_read_b64_tr_b16 a[4:5], v17 offset:24576
    ds_read_b64_tr_b16 a[6:7], v17 offset:25600
    s_waitcnt lgkmcnt(7)
    v_mfma_f32_32x32x16_bf16 v[96:111], a[24:27], a[36:39], v[96:111]
    ds_read_b64_tr_b16 a[8:9], v18 offset:24576
    ds_read_b64_tr_b16 a[10:11], v18 offset:25600
    s_add_u32 m0, s61, 115712
    s_add_u32 s66, s65, 32768
    buffer_load_dwordx4 v9, s[32:35], s66 offen sc1 lds
    s_waitcnt lgkmcnt(7)
    v_mfma_f32_32x32x16_bf16 v[112:127], a[28:31], a[36:39], v[112:127]
    ds_read_b64_tr_b16 a[12:13], v19 offset:24576
    ds_read_b64_tr_b16 a[14:15], v19 offset:25600
    s_waitcnt lgkmcnt(6)
    v_mfma_f32_32x32x16_bf16 v[64:79], a[0:3], a[32:35], v[64:79]
    ds_read_b128 a[36:39], v15 offset:16384
    ds_read_b64_tr_b16 a[16:17], v16 offset:28672
    ds_read_b64_tr_b16 a[18:19], v16 offset:29696
    s_add_u32 m0, s61, 116736
    s_add_u32 s66, s65, 65536
    buffer_load_dwordx4 v9, s[32:35], s66 offen sc1 lds
    s_waitcnt lgkmcnt(7)
    v_mfma_f32_32x32x16_bf16 v[80:95], a[4:7], a[32:35], v[80:95]
    ds_read_b64_tr_b16 a[20:21], v17 offset:28672
    ds_read_b64_tr_b16 a[22:23], v17 offset:29696
    s_waitcnt lgkmcnt(7)
    v_mfma_f32_32x32x16_bf16 v[96:111], a[8:11], a[32:35], v[96:111]
    ds_read_b64_tr_b16 a[24:25], v18 offset:28672
    ds_read_b64_tr_b16 a[26:27], v18 offset:29696
    s_add_u32 m0, s61, 117760
    s_add_u32 s66, s65, 98304
    buffer_load_dwordx4 v9, s[32:35], s66 offen sc1 lds
    s_waitcnt lgkmcnt(7)
    v_mfma_f32_32x32x16_bf16 v[112:127], a[12:15], a[32:35], v[112:127]
    ds_read_b64_tr_b16 a[28:29], v19 offset:28672
    ds_read_b64_tr_b16 a[30:31], v19 offset:29696
    s_waitcnt lgkmcnt(6)
    v_mfma_f32_32x32x16_bf16 v[64:79], a[16:19], a[36:39], v[64:79]
    s_waitcnt lgkmcnt(4)
    v_mfma_f32_32x32x16_bf16 v[80:95], a[20:23], a[36:39], v[80:95]
    s_waitcnt lgkmcnt(2)
    v_mfma_f32_32x32x16_bf16 v[96:111], a[24:27], a[36:39], v[96:111]
    s_waitcnt lgkmcnt(0)
    v_mfma_f32_32x32x16_bf16 v[112:127], a[28:31], a[36:39], v[112:127]
    s_waitcnt vmcnt(8)
    s_barrier
    ds_read_b128 a[32:35], v12 offset:32768
    ds_read_b64_tr_b16 a[0:1], v16 offset:32768
    ds_read_b64_tr_b16 a[2:3], v16 offset:33792
    ds_read_b64_tr_b16 a[4:5], v17 offset:32768
    ds_read_b64_tr_b16 a[6:7], v17 offset:33792
    ds_read_b64_tr_b16 a[8:9], v18 offset:32768
    ds_read_b64_tr_b16 a[10:11], v18 offset:33792
    ds_read_b64_tr_b16 a[12:13], v19 offset:32768
    ds_read_b64_tr_b16 a[14:15], v19 offset:33792
    s_add_u32 s67, s49, 32768
    s_add_u32 m0, s57, 49152
    s_nop 0
    buffer_load_dwordx4 v4, s[24:27], s67 offen nt lds
    buffer_load_dwordx4 v5, s[24:27], s67 offen offset:1024 nt lds
    s_waitcnt lgkmcnt(6)
    v_mfma_f32_32x32x16_bf16 v[64:79], a[0:3], a[32:35], v[64:79]
    ds_read_b128 a[36:39], v13 offset:32768
    ds_read_b64_tr_b16 a[16:17], v16 offset:36864
    ds_read_b64_tr_b16 a[18:19], v16 offset:37888
    buffer_load_dwordx4 v6, s[24:27], s67 offen offset:2048 nt lds
    s_waitcnt lgkmcnt(7)
    v_mfma_f32_32x32x16_bf16 v[80:95], a[4:7], a[32:35], v[80:95]
    ds_read_b64_tr_b16 a[20:21], v17 offset:36864
    ds_read_b64_tr_b16 a[22:23], v17 offset:37888
    s_waitcnt lgkmcnt(7)
    v_mfma_f32_32x32x16_bf16 v[96:111], a[8:11], a[32:35], v[96:111]
    ds_read_b64_tr_b16 a[24:25], v18 offset:36864
    ds_read_b64_tr_b16 a[26:27], v18 offset:37888
    buffer_load_dwordx4 v7, s[24:27], s67 offen offset:3072 nt lds
    s_waitcnt lgkmcnt(7)
    v_mfma_f32_32x32x16_bf16 v[112:127], a[12:15], a[32:35], v[112:127]
    ds_read_b64_tr_b16 a[28:29], v19 offset:36864
    ds_read_b64_tr_b16 a[30:31], v19 offset:37888
    s_waitcnt lgkmcnt(6)
    v_mfma_f32_32x32x16_bf16 v[64:79], a[16:19], a[36:39], v[64:79]
    ds_read_b128 a[32:35], v14 offset:32768
    ds_read_b64_tr_b16 a[0:1], v16 offset:40960
    ds_read_b64_tr_b16 a[2:3], v16 offset:41984
    s_add_u32 s67, s49, 36864
    s_add_u32 m0, s57, 53248
    s_nop 0
    buffer_load_dwordx4 v4, s[24:27], s67 offen nt lds
    s_waitcnt lgkmcnt(7)
    v_mfma_f32_32x32x16_bf16 v[80:95], a[20:23], a[36:39], v[80:95]
    ds_read_b64_tr_b16 a[4:5], v17 offset:40960
    ds_read_b64_tr_b16 a[6:7], v17 offset:41984
    s_waitcnt lgkmcnt(7)
    v_mfma_f32_32x32x16_bf16 v[96:111], a[24:27], a[36:39], v[96:111]
    ds_read_b64_tr_b16 a[8:9], v18 offset:40960
    ds_read_b64_tr_b16 a[10:11], v18 offset:41984
    buffer_load_dwordx4 v5, s[24:27], s67 offen offset:1024 nt lds
    s_waitcnt lgkmcnt(7)
    v_mfma_f32_32x32x16_bf16 v[112:127], a[28:31], a[36:39], v[112:127]
    ds_read_b64_tr_b16 a[12:13], v19 offset:40960
    ds_read_b64_tr_b16 a[14:15], v19 offset:41984
    s_waitcnt lgkmcnt(6)
    v_mfma_f32_32x32x16_bf16 v[64:79], a[0:3], a[32:35], v[64:79]
    ds_read_b128 a[36:39], v15 offset:32768
    ds_read_b64_tr_b16 a[16:17], v16 offset:45056
    ds_read_b64_tr_b16 a[18:19], v16 offset:46080
    buffer_load_dwordx4 v6, s[24:27], s67 offen offset:2048 nt lds
    s_waitcnt lgkmcnt(7)
    v_mfma_f32_32x32x16_bf16 v[80:95], a[4:7], a[32:35], v[80:95]
    ds_read_b64_tr_b16 a[20:21], v17 offset:45056
    ds_read_b64_tr_b16 a[22:23], v17 offset:46080
    s_waitcnt lgkmcnt(7)
    v_mfma_f32_32x32x16_bf16 v[96:111], a[8:11], a[32:35], v[96:111]
    ds_read_b64_tr_b16 a[24:25], v18 offset:45056
    ds_read_b64_tr_b16 a[26:27], v18 offset:46080
    buffer_load_dwordx4 v7, s[24:27], s67 offen offset:3072 nt lds
    s_waitcnt lgkmcnt(7)
    v_mfma_f32_32x32x16_bf16 v[112:127], a[12:15], a[32:35], v[112:127]
    ds_read_b64_tr_b16 a[28:29], v19 offset:45056
    ds_read_b64_tr_b16 a[30:31], v19 offset:46080
    s_waitcnt lgkmcnt(6)
    v_mfma_f32_32x32x16_bf16 v[64:79], a[16:19], a[36:39], v[64:79]
    s_waitcnt lgkmcnt(4)
    v_mfma_f32_32x32x16_bf16 v[80:95], a[20:23], a[36:39], v[80:95]
    s_waitcnt lgkmcnt(2)
    v_mfma_f32_32x32x16_bf16 v[96:111], a[24:27], a[36:39], v[96:111]
    s_waitcnt lgkmcnt(0)
    v_mfma_f32_32x32x16_bf16 v[112:127], a[28:31], a[36:39], v[112:127]
    s_waitcnt vmcnt(8)
    s_barrier
    ds_read_b128 a[32:35], v12 offset:0
    ds_read_b64_tr_b16 a[0:1], v16 offset:0
    ds_read_b64_tr_b16 a[2:3], v16 offset:1024
    ds_read_b64_tr_b16 a[4:5], v17 offset:0
    ds_read_b64_tr_b16 a[6:7], v17 offset:1024
    ds_read_b64_tr_b16 a[8:9], v18 offset:0
    ds_read_b64_tr_b16 a[10:11], v18 offset:1024
    ds_read_b64_tr_b16 a[12:13], v19 offset:0
    ds_read_b64_tr_b16 a[14:15], v19 offset:1024
    s_add_u32 s67, s49, 16384
    s_add_u32 m0, s57, 65536
    s_nop 0
    buffer_load_dwordx4 v8, s[28:31], s67 offen nt lds
    buffer_load_dwordx4 v8, s[28:31], s67 offen offset:1024 nt lds
    s_waitcnt lgkmcnt(6)
    v_mfma_f32_32x32x16_bf16 v[64:79], a[0:3], a[32:35], v[64:79]
    ds_read_b128 a[36:39], v13 offset:0
    ds_read_b64_tr_b16 a[16:17], v16 offset:4096
    ds_read_b64_tr_b16 a[18:19], v16 offset:5120
    buffer_load_dwordx4 v8, s[28:31], s67 offen offset:2048 nt lds
    s_waitcnt lgkmcnt(7)
    v_mfma_f32_32x32x16_bf16 v[80:95], a[4:7], a[32:35], v[80:95]
    ds_read_b64_tr_b16 a[20:21], v17 offset:4096
    ds_read_b64_tr_b16 a[22:23], v17 offset:5120
    s_waitcnt lgkmcnt(7)
    v_mfma_f32_32x32x16_bf16 v[96:111], a[8:11], a[32:35], v[96:111]
    ds_read_b64_tr_b16 a[24:25], v18 offset:4096
    ds_read_b64_tr_b16 a[26:27], v18 offset:5120
    buffer_load_dwordx4 v8, s[28:31], s67 offen offset:3072 nt lds
    s_waitcnt lgkmcnt(7)
    v_mfma_f32_32x32x16_bf16 v[112:127], a[12:15], a[32:35], v[112:127]
    ds_read_b64_tr_b16 a[28:29], v19 offset:4096
    ds_read_b64_tr_b16 a[30:31], v19 offset:5120
    s_waitcnt lgkmcnt(6)
    v_mfma_f32_32x32x16_bf16 v[64:79], a[16:19], a[36:39], v[64:79]
    ds_read_b128 a[32:35], v14 offset:0
    ds_read_b64_tr_b16 a[0:1], v16 offset:8192
    ds_read_b64_tr_b16 a[2:3], v16 offset:9216
    s_add_u32 s67, s49, 20480
    s_add_u32 m0, s57, 69632
    s_nop 0
    buffer_load_dwordx4 v8, s[28:31], s67 offen nt lds
    s_waitcnt lgkmcnt(7)
    v_mfma_f32_32x32x16_bf16 v[80:95], a[20:23], a[36:39], v[80:95]
    ds_read_b64_tr_b16 a[4:5], v17 offset:8192
    ds_read_b64_tr_b16 a[6:7], v17 offset:9216
    s_waitcnt lgkmcnt(7)
    v_mfma_f32_32x32x16_bf16 v[96:111], a[24:27], a[36:39], v[96:111]
    ds_read_b64_tr_b16 a[8:9], v18 offset:8192
    ds_read_b64_tr_b16 a[10:11], v18 offset:9216
    buffer_load_dwordx4 v8, s[28:31], s67 offen offset:1024 nt lds
    s_waitcnt lgkmcnt(7)
    v_mfma_f32_32x32x16_bf16 v[112:127], a[28:31], a[36:39], v[112:127]
    ds_read_b64_tr_b16 a[12:13], v19 offset:8192
    ds_read_b64_tr_b16 a[14:15], v19 offset:9216
    s_waitcnt lgkmcnt(6)
    v_mfma_f32_32x32x16_bf16 v[64:79], a[0:3], a[32:35], v[64:79]
    ds_read_b128 a[36:39], v15 offset:0
    ds_read_b64_tr_b16 a[16:17], v16 offset:12288
    ds_read_b64_tr_b16 a[18:19], v16 offset:13312
    buffer_load_dwordx4 v8, s[28:31], s67 offen offset:2048 nt lds
    s_waitcnt lgkmcnt(7)
    v_mfma_f32_32x32x16_bf16 v[80:95], a[4:7], a[32:35], v[80:95]
    ds_read_b64_tr_b16 a[20:21], v17 offset:12288
    ds_read_b64_tr_b16 a[22:23], v17 offset:13312
    s_waitcnt lgkmcnt(7)
    v_mfma_f32_32x32x16_bf16 v[96:111], a[8:11], a[32:35], v[96:111]
    ds_read_b64_tr_b16 a[24:25], v18 offset:12288
    ds_read_b64_tr_b16 a[26:27], v18 offset:13312
    buffer_load_dwordx4 v8, s[28:31], s67 offen offset:3072 nt lds
    s_waitcnt lgkmcnt(7)
    v_mfma_f32_32x32x16_bf16 v[112:127], a[12:15], a[32:35], v[112:127]
    ds_read_b64_tr_b16 a[28:29], v19 offset:12288
    ds_read_b64_tr_b16 a[30:31], v19 offset:13312
    s_waitcnt lgkmcnt(6)
    v_mfma_f32_32x32x16_bf16 v[64:79], a[16:19], a[36:39], v[64:79]
    s_waitcnt lgkmcnt(4)
    v_mfma_f32_32x32x16_bf16 v[80:95], a[20:23], a[36:39], v[80:95]
    s_waitcnt lgkmcnt(2)
    v_mfma_f32_32x32x16_bf16 v[96:111], a[24:27], a[36:39], v[96:111]
    s_waitcnt lgkmcnt(0)
    v_mfma_f32_32x32x16_bf16 v[112:127], a[28:31], a[36:39], v[112:127]
    s_barrier
    ds_read_b128 a[0:3], v20 offset:0
    ds_read_b128 a[4:7], v20 offset:8192
    ds_read_b128 a[8:11], v21 offset:0
    ds_read_b128 a[12:15], v21 offset:8192
    ds_read_b128 a[16:19], v22 offset:0
    ds_read_b128 a[20:23], v22 offset:8192
    ds_read_b128 a[24:27], v23 offset:0
    ds_read_b128 a[28:31], v23 offset:8192
    v_pk_mul_f32 v[64:65], v[64:65], s[72:73]
    v_pk_mul_f32 v[66:67], v[66:67], s[72:73]
    v_pk_mul_f32 v[68:69], v[68:69], s[72:73]
    v_pk_mul_f32 v[70:71], v[70:71], s[72:73]
    v_pk_mul_f32 v[72:73], v[72:73], s[72:73]
    v_pk_mul_f32 v[74:75], v[74:75], s[72:73]
    v_pk_mul_f32 v[76:77], v[76:77], s[72:73]
    v_pk_mul_f32 v[78:79], v[78:79], s[72:73]
    v_cvt_pk_bf16_f32 v128, v64, v65
    v_cvt_pk_bf16_f32 v129, v66, v67
    v_cvt_pk_bf16_f32 v130, v68, v69
    v_cvt_pk_bf16_f32 v131, v70, v71
    v_cvt_pk_bf16_f32 v132, v72, v73
    v_cvt_pk_bf16_f32 v133, v74, v75
    v_cvt_pk_bf16_f32 v134, v76, v77
    v_cvt_pk_bf16_f32 v135, v78, v79
    ds_read_b128 a[32:35], v24 offset:0
    ds_read_b128 a[36:39], v24 offset:8192
    ds_read_b128 a[40:43], v25 offset:0
    ds_read_b128 a[44:47], v25 offset:8192
    ds_write_b128 v11, v[160:163] offset:32768
    v_pk_mul_f32 v[80:81], v[80:81], s[72:73]
    v_pk_mul_f32 v[82:83], v[82:83], s[72:73]
    v_pk_mul_f32 v[84:85], v[84:85], s[72:73]
    v_pk_mul_f32 v[86:87], v[86:87], s[72:73]
    v_pk_mul_f32 v[88:89], v[88:89], s[72:73]
    v_pk_mul_f32 v[90:91], v[90:91], s[72:73]
    v_pk_mul_f32 v[92:93], v[92:93], s[72:73]
    v_pk_mul_f32 v[94:95], v[94:95], s[72:73]
    ds_write_b128 v11, v[164:167] offset:33792
    v_cvt_pk_bf16_f32 v136, v80, v81
    v_cvt_pk_bf16_f32 v137, v82, v83
    v_cvt_pk_bf16_f32 v138, v84, v85
    v_cvt_pk_bf16_f32 v139, v86, v87
    v_cvt_pk_bf16_f32 v140, v88, v89
    v_cvt_pk_bf16_f32 v141, v90, v91
    v_cvt_pk_bf16_f32 v142, v92, v93
    v_cvt_pk_bf16_f32 v143, v94, v95
    ds_read_b128 a[48:51], v26 offset:0
    ds_read_b128 a[52:55], v26 offset:8192
    ds_read_b128 a[56:59], v27 offset:0
    ds_read_b128 a[60:63], v27 offset:8192
    v_pk_mul_f32 v[96:97], v[96:97], s[72:73]
    v_pk_mul_f32 v[98:99], v[98:99], s[72:73]
    v_pk_mul_f32 v[100:101], v[100:101], s[72:73]
    v_pk_mul_f32 v[102:103], v[102:103], s[72:73]
    v_pk_mul_f32 v[104:105], v[104:105], s[72:73]
    v_pk_mul_f32 v[106:107], v[106:107], s[72:73]
    v_pk_mul_f32 v[108:109], v[108:109], s[72:73]
    v_pk_mul_f32 v[110:111], v[110:111], s[72:73]
    ds_write_b128 v11, v[168:171] offset:34816
    v_cvt_pk_bf16_f32 v144, v96, v97
    v_cvt_pk_bf16_f32 v145, v98, v99
    v_cvt_pk_bf16_f32 v146, v100, v101
    v_cvt_pk_bf16_f32 v147, v102, v103
    v_cvt_pk_bf16_f32 v148, v104, v105
    v_cvt_pk_bf16_f32 v149, v106, v107
    v_cvt_pk_bf16_f32 v150, v108, v109
    v_cvt_pk_bf16_f32 v151, v110, v111
    ds_write_b128 v11, v[172:175] offset:35840
    v_pk_mul_f32 v[112:113], v[112:113], s[72:73]
    v_pk_mul_f32 v[114:115], v[114:115], s[72:73]
    v_pk_mul_f32 v[116:117], v[116:117], s[72:73]
    v_pk_mul_f32 v[118:119], v[118:119], s[72:73]
    v_pk_mul_f32 v[120:121], v[120:121], s[72:73]
    v_pk_mul_f32 v[122:123], v[122:123], s[72:73]
    v_pk_mul_f32 v[124:125], v[124:125], s[72:73]
    v_pk_mul_f32 v[126:127], v[126:127], s[72:73]
    ds_write_b128 v11, v[176:179] offset:36864
    v_cvt_pk_bf16_f32 v152, v112, v113
    v_cvt_pk_bf16_f32 v153, v114, v115
    v_cvt_pk_bf16_f32 v154, v116, v117
    v_cvt_pk_bf16_f32 v155, v118, v119
    v_cvt_pk_bf16_f32 v156, v120, v121
    v_cvt_pk_bf16_f32 v157, v122, v123
    v_cvt_pk_bf16_f32 v158, v124, v125
    v_cvt_pk_bf16_f32 v159, v126, v127
    s_add_u32 s67, s49, 65536
    buffer_load_dwordx4 a[192:195], v4, s[24:27], s67 offen nt
    ds_write_b128 v11, v[180:183] offset:37888
    v_mov_b32 v35, v39
    v_mov_b32 v224, 0
    v_mov_b32 v225, 0
    s_waitcnt lgkmcnt(15)
    v_mfma_f32_32x32x16_bf16 v[64:79], a[0:3], v[128:131], 0
    ds_write_b128 v11, v[184:187] offset:38912
    s_waitcnt lgkmcnt(15)
    v_mfma_f32_32x32x16_bf16 v[80:95], a[4:7], v[128:131], 0
    buffer_load_dwordx4 a[196:199], v5, s[24:27], s67 offen offset:1024 nt
    s_waitcnt lgkmcnt(15)
    v_mfma_f32_32x32x16_bf16 v[64:79], a[8:11], v[132:135], v[64:79]
    ds_write_b128 v11, v[188:191] offset:39936
    s_waitcnt lgkmcnt(15)
    v_mfma_f32_32x32x16_bf16 v[80:95], a[12:15], v[132:135], v[80:95]
    s_waitcnt lgkmcnt(15)
    v_mfma_f32_32x32x16_bf16 v[64:79], a[16:19], v[136:139], v[64:79]
    buffer_load_dwordx4 a[200:203], v6, s[24:27], s67 offen offset:2048 nt
    s_waitcnt lgkmcnt(15)
    v_mfma_f32_32x32x16_bf16 v[80:95], a[20:23], v[136:139], v[80:95]
    s_waitcnt lgkmcnt(15)
    v_mfma_f32_32x32x16_bf16 v[64:79], a[24:27], v[140:143], v[64:79]
    buffer_load_dwordx4 a[204:207], v7, s[24:27], s67 offen offset:3072 nt
    s_waitcnt lgkmcnt(15)
    v_mfma_f32_32x32x16_bf16 v[80:95], a[28:31], v[140:143], v[80:95]
    s_waitcnt lgkmcnt(15)
    v_mfma_f32_32x32x16_bf16 v[64:79], a[32:35], v[144:147], v[64:79]
    s_waitcnt lgkmcnt(14)
    v_mfma_f32_32x32x16_bf16 v[80:95], a[36:39], v[144:147], v[80:95]
    s_add_u32 s67, s49, 69632
    buffer_load_dwordx4 a[208:211], v4, s[24:27], s67 offen nt
    s_waitcnt lgkmcnt(13)
    v_mfma_f32_32x32x16_bf16 v[64:79], a[40:43], v[148:151], v[64:79]
    s_waitcnt lgkmcnt(12)
    v_mfma_f32_32x32x16_bf16 v[80:95], a[44:47], v[148:151], v[80:95]
    buffer_load_dwordx4 a[212:215], v5, s[24:27], s67 offen offset:1024 nt
    s_waitcnt lgkmcnt(9)
    v_mfma_f32_32x32x16_bf16 v[64:79], a[48:51], v[152:155], v[64:79]
    s_waitcnt lgkmcnt(8)
    v_mfma_f32_32x32x16_bf16 v[80:95], a[52:55], v[152:155], v[80:95]
    s_waitcnt lgkmcnt(7)
    v_mfma_f32_32x32x16_bf16 v[64:79], a[56:59], v[156:159], v[64:79]
    buffer_load_dwordx4 a[216:219], v6, s[24:27], s67 offen offset:2048 nt
    s_waitcnt lgkmcnt(6)
    v_mfma_f32_32x32x16_bf16 v[80:95], a[60:63], v[156:159], v[80:95]
    s_waitcnt lgkmcnt(0)
    ds_read_b128 a[64:67], v20 offset:16384
    ds_read_b128 a[68:71], v20 offset:24576
    ds_read_b128 a[72:75], v21 offset:16384
    ds_read_b128 a[76:79], v21 offset:24576
    ds_read_b128 a[80:83], v22 offset:16384
    ds_read_b128 a[84:87], v22 offset:24576
    ds_read_b128 a[88:91], v23 offset:16384
    ds_read_b128 a[92:95], v23 offset:24576
    ds_read_b128 a[96:99], v24 offset:16384
    ds_read_b128 a[100:103], v24 offset:24576
    ds_read_b128 a[104:107], v25 offset:16384
    ds_read_b128 a[108:111], v25 offset:24576
    ds_read_b128 a[112:115], v26 offset:16384
    ds_read_b128 a[116:119], v26 offset:24576
    ds_read_b128 a[120:123], v27 offset:16384
    ds_read_b128 a[124:127], v27 offset:24576
    v_max3_f32 v32, v64, v65, v66
    v_max3_f32 v33, v80, v81, v82
    v_max3_f32 v32, v32, v67, v68
    v_max3_f32 v33, v33, v83, v84
    v_max3_f32 v32, v32, v69, v70
    v_max3_f32 v33, v33, v85, v86
    v_max3_f32 v32, v32, v71, v72
    v_max3_f32 v33, v33, v87, v88
    v_max3_f32 v32, v32, v73, v74
    v_max3_f32 v33, v33, v89, v90
    v_max3_f32 v32, v32, v75, v76
    v_max3_f32 v33, v33, v91, v92
    v_max3_f32 v32, v32, v77, v78
    v_max3_f32 v33, v33, v93, v94
    v_max3_f32 v32, v32, v79, v95
    v_max_f32 v32, v32, v33
    v_mov_b32 v33, v32
    s_nop 1
    v_permlane32_swap_b32 v32, v33
    v_max_f32 v32, v32, v33
    v_sub_f32 v240, 0, v32
    v_sub_f32 v241, 0, v32
    v_sub_f32 v242, 0, v32
    v_sub_f32 v243, 0, v32
    v_sub_f32 v244, 0, v32
    v_sub_f32 v245, 0, v32
    v_sub_f32 v246, 0, v32
    v_sub_f32 v247, 0, v32
    v_sub_f32 v248, 0, v32
    v_sub_f32 v249, 0, v32
    v_sub_f32 v250, 0, v32
    v_sub_f32 v251, 0, v32
    v_sub_f32 v252, 0, v32
    v_sub_f32 v253, 0, v32
    v_sub_f32 v254, 0, v32
    v_sub_f32 v255, 0, v32
    v_sub_f32 v64, v64, v32
    v_sub_f32 v65, v65, v32
    v_sub_f32 v66, v66, v32
    v_sub_f32 v67, v67, v32
    v_sub_f32 v68, v68, v32
    v_sub_f32 v69, v69, v32
    v_sub_f32 v70, v70, v32
    v_sub_f32 v71, v71, v32
    v_sub_f32 v72, v72, v32
    v_sub_f32 v73, v73, v32
    v_sub_f32 v74, v74, v32
    v_sub_f32 v75, v75, v32
    v_sub_f32 v76, v76, v32
    v_sub_f32 v77, v77, v32
    v_sub_f32 v78, v78, v32
    v_sub_f32 v79, v79, v32
    v_sub_f32 v80, v80, v32
    v_sub_f32 v81, v81, v32
    v_sub_f32 v82, v82, v32
    v_sub_f32 v83, v83, v32
    v_sub_f32 v84, v84, v32
    v_sub_f32 v85, v85, v32
    v_sub_f32 v86, v86, v32
    v_sub_f32 v87, v87, v32
    v_sub_f32 v88, v88, v32
    v_sub_f32 v89, v89, v32
    v_sub_f32 v90, v90, v32
    v_sub_f32 v91, v91, v32
    v_sub_f32 v92, v92, v32
    v_sub_f32 v93, v93, v32
    v_sub_f32 v94, v94, v32
    v_sub_f32 v95, v95, v32
    s_waitcnt lgkmcnt(0)
    s_barrier
    v_mfma_f32_32x32x16_bf16 v[96:111], a[64:67], v[128:131], v[240:255]
    v_exp_f32 v64, v64
    v_exp_f32 v65, v65
    ds_read_b64_tr_b16 a[0:1], v28 offset:32768
    ds_read_b64_tr_b16 a[2:3], v28 offset:34816
    ds_write_b128 v11, a[128:131] offset:0
    buffer_load_dwordx4 a[220:223], v7, s[24:27], s67 offen offset:3072 nt
    v_mfma_f32_32x32x16_bf16 v[112:127], a[68:71], v[128:131], v[240:255]
    v_exp_f32 v66, v66
    v_exp_f32 v67, v67
    ds_read_b64_tr_b16 a[4:5], v29 offset:32768
    ds_read_b64_tr_b16 a[6:7], v29 offset:34816
    ds_write_b128 v11, a[132:135] offset:1024
    v_mfma_f32_32x32x16_bf16 v[96:111], a[72:75], v[132:135], v[96:111]
    v_cvt_pk_bf16_f32 v48, v64, v65
    v_exp_f32 v68, v68
    ds_read_b64_tr_b16 a[8:9], v30 offset:32768
    ds_read_b64_tr_b16 a[10:11], v30 offset:34816
    ds_read_b64_tr_b16 a[12:13], v31 offset:32768
    ds_write_b128 v11, a[136:139] offset:2048
    v_mfma_f32_32x32x16_bf16 v[112:127], a[76:79], v[132:135], v[112:127]
    v_exp_f32 v69, v69
    v_cvt_pk_bf16_f32 v49, v66, v67
    v_exp_f32 v70, v70
    ds_read_b64_tr_b16 a[14:15], v31 offset:34816
    ds_read_b64_tr_b16 a[16:17], v28 offset:36864
    s_add_u32 s67, s49, 49152
    buffer_load_dwordx4 a[224:227], v8, s[28:31], s67 offen nt
    ds_write_b128 v11, a[140:143] offset:3072
    v_mfma_f32_32x32x16_bf16 v[96:111], a[80:83], v[136:139], v[96:111]
    v_exp_f32 v71, v71
    v_cvt_pk_bf16_f32 v50, v68, v69
    ds_read_b64_tr_b16 a[18:19], v28 offset:38912
    ds_read_b64_tr_b16 a[20:21], v29 offset:36864
    ds_read_b64_tr_b16 a[22:23], v29 offset:38912
    ds_write_b128 v11, a[144:147] offset:4096
    v_mfma_f32_32x32x16_bf16 v[112:127], a[84:87], v[136:139], v[112:127]
    v_cvt_pk_bf16_f32 v51, v70, v71
    v_exp_f32 v72, v72
    ds_read_b64_tr_b16 a[24:25], v30 offset:36864
    ds_read_b64_tr_b16 a[26:27], v30 offset:38912
    v_mfma_f32_32x32x16_bf16 v[96:111], a[88:91], v[140:143], v[96:111]
    v_exp_f32 v73, v73
    v_exp_f32 v74, v74
    ds_read_b64_tr_b16 a[28:29], v31 offset:36864
    ds_read_b64_tr_b16 a[30:31], v31 offset:38912
    ds_read_b64_tr_b16 a[32:33], v28 offset:40960
    ds_write_b128 v11, a[148:151] offset:5120
    buffer_load_dwordx4 a[228:231], v8, s[28:31], s67 offen offset:1024 nt
    v_mfma_f32_32x32x16_bf16 v[112:127], a[92:95], v[140:143], v[112:127]
    v_exp_f32 v75, v75
    v_cvt_pk_bf16_f32 v52, v72, v73
    v_exp_f32 v76, v76
    ds_read_b64_tr_b16 a[34:35], v28 offset:43008
    ds_read_b64_tr_b16 a[36:37], v29 offset:40960
    ds_write_b128 v11, a[152:155] offset:6144
    v_mfma_f32_32x32x16_bf16 v[96:111], a[96:99], v[144:147], v[96:111]
    v_exp_f32 v77, v77
    v_cvt_pk_bf16_f32 v53, v74, v75
    ds_read_b64_tr_b16 a[38:39], v29 offset:43008
    ds_read_b64_tr_b16 a[40:41], v30 offset:40960
    ds_read_b64_tr_b16 a[42:43], v30 offset:43008
    ds_write_b128 v11, a[156:159] offset:7168
    v_mfma_f32_32x32x16_bf16 v[112:127], a[100:103], v[144:147], v[112:127]
    v_exp_f32 v78, v78
    v_exp_f32 v79, v79
    ds_read_b64_tr_b16 a[44:45], v31 offset:40960
    ds_read_b64_tr_b16 a[46:47], v31 offset:43008
    buffer_load_dwordx4 a[232:235], v8, s[28:31], s67 offen offset:2048 nt
    ds_write_b128 v11, a[160:163] offset:16384
    v_mfma_f32_32x32x16_bf16 v[96:111], a[104:107], v[148:151], v[96:111]
    v_cvt_pk_bf16_f32 v54, v76, v77
    v_cvt_pk_bf16_f32 v55, v78, v79
    ds_read_b64_tr_b16 a[48:49], v28 offset:45056
    ds_read_b64_tr_b16 a[50:51], v28 offset:47104
    ds_read_b64_tr_b16 a[52:53], v29 offset:45056
    ds_write_b128 v11, a[164:167] offset:17408
    v_mfma_f32_32x32x16_bf16 v[112:127], a[108:111], v[148:151], v[112:127]
    v_exp_f32 v80, v80
    v_exp_f32 v81, v81
    v_exp_f32 v82, v82
    ds_read_b64_tr_b16 a[54:55], v29 offset:47104
    ds_read_b64_tr_b16 a[56:57], v30 offset:45056
    v_mfma_f32_32x32x16_bf16 v[96:111], a[112:115], v[152:155], v[96:111]
    v_exp_f32 v83, v83
    v_cvt_pk_bf16_f32 v56, v80, v81
    ds_read_b64_tr_b16 a[58:59], v30 offset:47104
    ds_read_b64_tr_b16 a[60:61], v31 offset:45056
    ds_read_b64_tr_b16 a[62:63], v31 offset:47104
    ds_write_b128 v11, a[168:171] offset:18432
    buffer_load_dwordx4 a[236:239], v8, s[28:31], s67 offen offset:3072 nt
    v_mfma_f32_32x32x16_bf16 v[112:127], a[116:119], v[152:155], v[112:127]
    v_exp_f32 v84, v84
    v_exp_f32 v85, v85
    ds_write_b128 v11, a[172:175] offset:19456
    v_mfma_f32_32x32x16_bf16 v[96:111], a[120:123], v[156:159], v[96:111]
    v_cvt_pk_bf16_f32 v57, v82, v83
    v_exp_f32 v86, v86
    ds_write_b128 v11, a[176:179] offset:20480
    v_mfma_f32_32x32x16_bf16 v[112:127], a[124:127], v[156:159], v[112:127]
    v_exp_f32 v87, v87
    v_cvt_pk_bf16_f32 v58, v84, v85
    v_cvt_pk_bf16_f32 v59, v86, v87
    ds_write_b128 v11, a[180:183] offset:21504
    s_add_u32 s67, s49, 53248
    buffer_load_dwordx4 a[240:243], v8, s[28:31], s67 offen nt
    s_waitcnt vmcnt(21) lgkmcnt(0)
    s_barrier
    v_mfma_f32_32x32x16_bf16 v[160:175], a[0:3], v[48:51], 0
    v_exp_f32 v88, v88
    v_exp_f32 v89, v89
    ds_read_b128 a[64:67], v20 offset:49152
    ds_write_b128 v11, a[184:187] offset:22528
    v_mfma_f32_32x32x16_bf16 v[176:191], a[4:7], v[48:51], 0
    v_exp_f32 v90, v90
    v_exp_f32 v91, v91
    v_cvt_pk_bf16_f32 v60, v88, v89
    ds_read_b128 a[68:71], v20 offset:57344
    v_mfma_f32_32x32x16_bf16 v[192:207], a[8:11], v[48:51], 0
    v_exp_f32 v92, v92
    v_exp_f32 v93, v93
    v_cvt_pk_bf16_f32 v61, v90, v91
    ds_read_b128 a[72:75], v21 offset:49152
    ds_write_b128 v11, a[188:191] offset:23552
    buffer_load_dwordx4 a[244:247], v8, s[28:31], s67 offen offset:1024 nt
    v_mfma_f32_32x32x16_bf16 v[208:223], a[12:15], v[48:51], 0
    v_exp_f32 v94, v94
    v_exp_f32 v95, v95
    v_cvt_pk_bf16_f32 v62, v92, v93
    ds_read_b128 a[76:79], v21 offset:57344
    v_mfma_f32_32x32x16_bf16 v[160:175], a[16:19], v[52:55], v[160:175]
    v_cvt_pk_bf16_f32 v63, v94, v95
    v_max3_f32 v32, v96, v97, v98
    v_max3_f32 v33, v112, v113, v114
    ds_read_b128 a[80:83], v22 offset:49152
    ds_read_b128 a[84:87], v22 offset:57344
    v_mfma_f32_32x32x16_bf16 v[176:191], a[20:23], v[52:55], v[176:191]
    v_max3_f32 v32, v32, v99, v100
    v_max3_f32 v33, v33, v115, v116
    v_max3_f32 v32, v32, v101, v102
    ds_read_b128 a[88:91], v23 offset:49152
    v_mfma_f32_32x32x16_bf16 v[192:207], a[24:27], v[52:55], v[192:207]
    v_max3_f32 v33, v33, v117, v118
    v_max3_f32 v32, v32, v103, v104
    v_max3_f32 v33, v33, v119, v120
    ds_read_b128 a[92:95], v23 offset:57344
    buffer_load_dwordx4 a[248:251], v8, s[28:31], s67 offen offset:2048 nt
    v_mfma_f32_32x32x16_bf16 v[208:223], a[28:31], v[52:55], v[208:223]
    v_max3_f32 v32, v32, v105, v106
    v_max3_f32 v33, v33, v121, v122
    v_max3_f32 v32, v32, v107, v108
    ds_read_b128 a[96:99], v24 offset:49152
    v_mfma_f32_32x32x16_bf16 v[160:175], a[32:35], v[56:59], v[160:175]
    v_max3_f32 v33, v33, v123, v124
    v_max3_f32 v32, v32, v109, v110
    v_max3_f32 v33, v33, v125, v126
    ds_read_b128 a[100:103], v24 offset:57344
    ds_read_b128 a[104:107], v25 offset:49152
    v_mfma_f32_32x32x16_bf16 v[176:191], a[36:39], v[56:59], v[176:191]
    v_max3_f32 v32, v32, v111, v127
    v_max_f32 v32, v32, v33
    v_pk_add_f32 v[224:225], v[224:225], v[64:65]
    ds_read_b128 a[108:111], v25 offset:57344
    buffer_load_dwordx4 a[252:255], v8, s[28:31], s67 offen offset:3072 nt
    v_mfma_f32_32x32x16_bf16 v[192:207], a[40:43], v[56:59], v[192:207]
    v_pk_add_f32 v[224:225], v[224:225], v[66:67]
    v_pk_add_f32 v[224:225], v[224:225], v[68:69]
    v_pk_add_f32 v[224:225], v[224:225], v[70:71]
    ds_read_b128 a[112:115], v26 offset:49152
    v_mfma_f32_32x32x16_bf16 v[208:223], a[44:47], v[56:59], v[208:223]
    v_pk_add_f32 v[224:225], v[224:225], v[72:73]
    v_pk_add_f32 v[224:225], v[224:225], v[74:75]
    v_pk_add_f32 v[224:225], v[224:225], v[76:77]
    ds_read_b128 a[116:119], v26 offset:57344
    v_mfma_f32_32x32x16_bf16 v[160:175], a[48:51], v[60:63], v[160:175]
    v_pk_add_f32 v[224:225], v[224:225], v[78:79]
    v_pk_add_f32 v[224:225], v[224:225], v[80:81]
    v_pk_add_f32 v[224:225], v[224:225], v[82:83]
    ds_read_b128 a[120:123], v27 offset:49152
    ds_read_b128 a[124:127], v27 offset:57344
    s_add_u32 s67, s49, 81920
    buffer_load_dwordx4 a[128:131], v4, s[24:27], s67 offen nt
    v_mfma_f32_32x32x16_bf16 v[176:191], a[52:55], v[60:63], v[176:191]
    v_pk_add_f32 v[224:225], v[224:225], v[84:85]
    v_pk_add_f32 v[224:225], v[224:225], v[86:87]
    v_pk_add_f32 v[224:225], v[224:225], v[88:89]
    v_mfma_f32_32x32x16_bf16 v[192:207], a[56:59], v[60:63], v[192:207]
    v_pk_add_f32 v[224:225], v[224:225], v[90:91]
    v_pk_add_f32 v[224:225], v[224:225], v[92:93]
    v_pk_add_f32 v[224:225], v[224:225], v[94:95]
    v_mfma_f32_32x32x16_bf16 v[208:223], a[60:63], v[60:63], v[208:223]
    buffer_load_dwordx4 a[132:135], v5, s[24:27], s67 offen offset:1024 nt
    v_cmp_lt_f32 vcc, 0x41000000, v32
    s_cbranch_vccz L_back1
    s_call_b64 s[72:73], L_rare1
L_back1:
    s_waitcnt vmcnt(18) lgkmcnt(0)
    s_barrier
    v_add_u32 v28, 0x4000, v28
    v_add_u32 v29, 0x4000, v29
    v_add_u32 v30, 0x4000, v30
    v_add_u32 v31, 0x4000, v31
    v_mfma_f32_32x32x16_bf16 v[64:79], a[64:67], v[128:131], v[240:255]
    v_exp_f32 v96, v96
    v_exp_f32 v97, v97
    ds_read_b64_tr_b16 a[0:1], v28 offset:49152
    ds_read_b64_tr_b16 a[2:3], v28 offset:51200
    v_mfma_f32_32x32x16_bf16 v[80:95], a[68:71], v[128:131], v[240:255]
    v_exp_f32 v98, v98
    v_exp_f32 v99, v99
    ds_read_b64_tr_b16 a[4:5], v29 offset:49152
    ds_read_b64_tr_b16 a[6:7], v29 offset:51200
    v_mfma_f32_32x32x16_bf16 v[64:79], a[72:75], v[132:135], v[64:79]
    v_cvt_pk_bf16_f32 v48, v96, v97
    v_exp_f32 v100, v100
    ds_read_b64_tr_b16 a[8:9], v30 offset:49152
    ds_read_b64_tr_b16 a[10:11], v30 offset:51200
    ds_read_b64_tr_b16 a[12:13], v31 offset:49152
    buffer_load_dwordx4 a[136:139], v6, s[24:27], s67 offen offset:2048 nt
    v_mfma_f32_32x32x16_bf16 v[80:95], a[76:79], v[132:135], v[80:95]
    v_exp_f32 v101, v101
    v_cvt_pk_bf16_f32 v49, v98, v99
    v_exp_f32 v102, v102
    ds_read_b64_tr_b16 a[14:15], v31 offset:51200
    ds_read_b64_tr_b16 a[16:17], v28 offset:53248
    v_mfma_f32_32x32x16_bf16 v[64:79], a[80:83], v[136:139], v[64:79]
    v_exp_f32 v103, v103
    v_cvt_pk_bf16_f32 v50, v100, v101
    ds_read_b64_tr_b16 a[18:19], v28 offset:55296
    ds_read_b64_tr_b16 a[20:21], v29 offset:53248
    ds_read_b64_tr_b16 a[22:23], v29 offset:55296
    v_mfma_f32_32x32x16_bf16 v[80:95], a[84:87], v[136:139], v[80:95]
    v_cvt_pk_bf16_f32 v51, v102, v103
    v_exp_f32 v104, v104
    ds_read_b64_tr_b16 a[24:25], v30 offset:53248
    ds_read_b64_tr_b16 a[26:27], v30 offset:55296
    buffer_load_dwordx4 a[140:143], v7, s[24:27], s67 offen offset:3072 nt
    v_mfma_f32_32x32x16_bf16 v[64:79], a[88:91], v[140:143], v[64:79]
    v_exp_f32 v105, v105
    v_exp_f32 v106, v106
    ds_read_b64_tr_b16 a[28:29], v31 offset:53248
    ds_read_b64_tr_b16 a[30:31], v31 offset:55296
    ds_read_b64_tr_b16 a[32:33], v28 offset:57344
    v_mfma_f32_32x32x16_bf16 v[80:95], a[92:95], v[140:143], v[80:95]
    v_exp_f32 v107, v107
    v_cvt_pk_bf16_f32 v52, v104, v105
    v_exp_f32 v108, v108
    ds_read_b64_tr_b16 a[34:35], v28 offset:59392
    ds_read_b64_tr_b16 a[36:37], v29 offset:57344
    v_mfma_f32_32x32x16_bf16 v[64:79], a[96:99], v[144:147], v[64:79]
    v_exp_f32 v109, v109
    v_cvt_pk_bf16_f32 v53, v106, v107
    ds_read_b64_tr_b16 a[38:39], v29 offset:59392
    ds_read_b64_tr_b16 a[40:41], v30 offset:57344
    ds_read_b64_tr_b16 a[42:43], v30 offset:59392
    v_mfma_f32_32x32x16_bf16 v[80:95], a[100:103], v[144:147], v[80:95]
    v_exp_f32 v110, v110
    v_exp_f32 v111, v111
    ds_read_b64_tr_b16 a[44:45], v31 offset:57344
    ds_read_b64_tr_b16 a[46:47], v31 offset:59392
    s_add_u32 s67, s49, 86016
    buffer_load_dwordx4 a[144:147], v4, s[24:27], s67 offen nt
    v_mfma_f32_32x32x16_bf16 v[64:79], a[104:107], v[148:151], v[64:79]
    v_cvt_pk_bf16_f32 v54, v108, v109
    v_cvt_pk_bf16_f32 v55, v110, v111
    ds_read_b64_tr_b16 a[48:49], v28 offset:61440
    ds_read_b64_tr_b16 a[50:51], v28 offset:63488
    ds_read_b64_tr_b16 a[52:53], v29 offset:61440
    v_mfma_f32_32x32x16_bf16 v[80:95], a[108:111], v[148:151], v[80:95]
    v_exp_f32 v112, v112
    v_exp_f32 v113, v113
    v_exp_f32 v114, v114
    ds_read_b64_tr_b16 a[54:55], v29 offset:63488
    ds_read_b64_tr_b16 a[56:57], v30 offset:61440
    s_waitcnt vmcnt(13)
    ds_write_b128 v11, a[192:195] offset:32768
    v_mfma_f32_32x32x16_bf16 v[64:79], a[112:115], v[152:155], v[64:79]
    v_exp_f32 v115, v115
    v_cvt_pk_bf16_f32 v56, v112, v113
    ds_read_b64_tr_b16 a[58:59], v30 offset:63488
    ds_read_b64_tr_b16 a[60:61], v31 offset:61440
    ds_read_b64_tr_b16 a[62:63], v31 offset:63488
    buffer_load_dwordx4 a[148:151], v5, s[24:27], s67 offen offset:1024 nt
    ds_write_b128 v11, a[196:199] offset:33792
    v_mfma_f32_32x32x16_bf16 v[80:95], a[116:119], v[152:155], v[80:95]
    v_exp_f32 v116, v116
    v_exp_f32 v117, v117
    ds_write_b128 v11, a[200:203] offset:34816
    v_mfma_f32_32x32x16_bf16 v[64:79], a[120:123], v[156:159], v[64:79]
    v_cvt_pk_bf16_f32 v57, v114, v115
    v_exp_f32 v118, v118
    ds_write_b128 v11, a[204:207] offset:35840
    v_mfma_f32_32x32x16_bf16 v[80:95], a[124:127], v[156:159], v[80:95]
    v_exp_f32 v119, v119
    v_cvt_pk_bf16_f32 v58, v116, v117
    v_cvt_pk_bf16_f32 v59, v118, v119
    buffer_load_dwordx4 a[152:155], v6, s[24:27], s67 offen offset:2048 nt
    ds_write_b128 v11, a[208:211] offset:36864
    s_waitcnt lgkmcnt(0)
    s_barrier
    v_mfma_f32_32x32x16_bf16 v[160:175], a[0:3], v[48:51], v[160:175]
    v_exp_f32 v120, v120
    v_exp_f32 v121, v121
    ds_read_b128 a[64:67], v20 offset:0
    v_mfma_f32_32x32x16_bf16 v[176:191], a[4:7], v[48:51], v[176:191]
    v_exp_f32 v122, v122
    v_exp_f32 v123, v123
    v_cvt_pk_bf16_f32 v60, v120, v121
    ds_read_b128 a[68:71], v20 offset:8192
    ds_write_b128 v11, a[212:215] offset:37888
    v_mfma_f32_32x32x16_bf16 v[192:207], a[8:11], v[48:51], v[192:207]
    v_exp_f32 v124, v124
    v_exp_f32 v125, v125
    v_cvt_pk_bf16_f32 v61, v122, v123
    ds_read_b128 a[72:75], v21 offset:0
    ds_write_b128 v11, a[216:219] offset:38912
    buffer_load_dwordx4 a[156:159], v7, s[24:27], s67 offen offset:3072 nt
    v_mfma_f32_32x32x16_bf16 v[208:223], a[12:15], v[48:51], v[208:223]
    v_exp_f32 v126, v126
    v_exp_f32 v127, v127
    v_cvt_pk_bf16_f32 v62, v124, v125
    ds_read_b128 a[76:79], v21 offset:8192
    ds_write_b128 v11, a[220:223] offset:39936
    v_mfma_f32_32x32x16_bf16 v[160:175], a[16:19], v[52:55], v[160:175]
    v_cvt_pk_bf16_f32 v63, v126, v127
    v_max3_f32 v32, v64, v65, v66
    v_max3_f32 v33, v80, v81, v82
    ds_read_b128 a[80:83], v22 offset:0
    ds_read_b128 a[84:87], v22 offset:8192
    v_mfma_f32_32x32x16_bf16 v[176:191], a[20:23], v[52:55], v[176:191]
    v_max3_f32 v32, v32, v67, v68
    v_max3_f32 v33, v33, v83, v84
    v_max3_f32 v32, v32, v69, v70
    ds_read_b128 a[88:91], v23 offset:0
    s_add_u32 s67, s49, 65536
    buffer_load_dwordx4 a[160:163], v8, s[28:31], s67 offen nt
    v_mfma_f32_32x32x16_bf16 v[192:207], a[24:27], v[52:55], v[192:207]
    v_max3_f32 v33, v33, v85, v86
    v_max3_f32 v32, v32, v71, v72
    v_max3_f32 v33, v33, v87, v88
    ds_read_b128 a[92:95], v23 offset:8192
    v_mfma_f32_32x32x16_bf16 v[208:223], a[28:31], v[52:55], v[208:223]
    v_max3_f32 v32, v32, v73, v74
    v_max3_f32 v33, v33, v89, v90
    v_max3_f32 v32, v32, v75, v76
    ds_read_b128 a[96:99], v24 offset:0
    v_mfma_f32_32x32x16_bf16 v[160:175], a[32:35], v[56:59], v[160:175]
    v_max3_f32 v33, v33, v91, v92
    v_max3_f32 v32, v32, v77, v78
    v_max3_f32 v33, v33, v93, v94
    ds_read_b128 a[100:103], v24 offset:8192
    ds_read_b128 a[104:107], v25 offset:0
    v_mfma_f32_32x32x16_bf16 v[176:191], a[36:39], v[56:59], v[176:191]
    v_max3_f32 v32, v32, v79, v95
    v_max_f32 v32, v32, v33
    v_pk_add_f32 v[224:225], v[224:225], v[96:97]
    ds_read_b128 a[108:111], v25 offset:8192
    buffer_load_dwordx4 a[164:167], v8, s[28:31], s67 offen offset:1024 nt
    v_mfma_f32_32x32x16_bf16 v[192:207], a[40:43], v[56:59], v[192:207]
    v_pk_add_f32 v[224:225], v[224:225], v[98:99]
    v_pk_add_f32 v[224:225], v[224:225], v[100:101]
    v_pk_add_f32 v[224:225], v[224:225], v[102:103]
    ds_read_b128 a[112:115], v26 offset:0
    v_mfma_f32_32x32x16_bf16 v[208:223], a[44:47], v[56:59], v[208:223]
    v_pk_add_f32 v[224:225], v[224:225], v[104:105]
    v_pk_add_f32 v[224:225], v[224:225], v[106:107]
    v_pk_add_f32 v[224:225], v[224:225], v[108:109]
    ds_read_b128 a[116:119], v26 offset:8192
    v_mfma_f32_32x32x16_bf16 v[160:175], a[48:51], v[60:63], v[160:175]
    v_pk_add_f32 v[224:225], v[224:225], v[110:111]
    v_pk_add_f32 v[224:225], v[224:225], v[112:113]
    v_pk_add_f32 v[224:225], v[224:225], v[114:115]
    ds_read_b128 a[120:123], v27 offset:0
    ds_read_b128 a[124:127], v27 offset:8192
    buffer_load_dwordx4 a[168:171], v8, s[28:31], s67 offen offset:2048 nt
    v_mfma_f32_32x32x16_bf16 v[176:191], a[52:55], v[60:63], v[176:191]
    v_pk_add_f32 v[224:225], v[224:225], v[116:117]
    v_pk_add_f32 v[224:225], v[224:225], v[118:119]
    v_pk_add_f32 v[224:225], v[224:225], v[120:121]
    v_mfma_f32_32x32x16_bf16 v[192:207], a[56:59], v[60:63], v[192:207]
    v_pk_add_f32 v[224:225], v[224:225], v[122:123]
    v_pk_add_f32 v[224:225], v[224:225], v[124:125]
    v_pk_add_f32 v[224:225], v[224:225], v[126:127]
    v_mfma_f32_32x32x16_bf16 v[208:223], a[60:63], v[60:63], v[208:223]
    buffer_load_dwordx4 a[172:175], v8, s[28:31], s67 offen offset:3072 nt
    v_cmp_lt_f32 vcc, 0x41000000, v32
    s_cbranch_vccz L_back2
    s_call_b64 s[72:73], L_rare0
L_back2:
    s_waitcnt lgkmcnt(0)
    s_barrier
    v_mfma_f32_32x32x16_bf16 v[96:111], a[64:67], v[128:131], v[240:255]
    v_exp_f32 v64, v64
    v_exp_f32 v65, v65
    ds_read_b64_tr_b16 a[0:1], v28 offset:0
    ds_read_b64_tr_b16 a[2:3], v28 offset:2048
    v_mfma_f32_32x32x16_bf16 v[112:127], a[68:71], v[128:131], v[240:255]
    v_exp_f32 v66, v66
    v_exp_f32 v67, v67
    ds_read_b64_tr_b16 a[4:5], v29 offset:0
    ds_read_b64_tr_b16 a[6:7], v29 offset:2048
    v_mfma_f32_32x32x16_bf16 v[96:111], a[72:75], v[132:135], v[96:111]
    v_cvt_pk_bf16_f32 v48, v64, v65
    v_exp_f32 v68, v68
    ds_read_b64_tr_b16 a[8:9], v30 offset:0
    ds_read_b64_tr_b16 a[10:11], v30 offset:2048
    ds_read_b64_tr_b16 a[12:13], v31 offset:0
    s_add_u32 s67, s49, 69632
    buffer_load_dwordx4 a[176:179], v8, s[28:31], s67 offen nt
    v_mfma_f32_32x32x16_bf16 v[112:127], a[76:79], v[132:135], v[112:127]
    v_exp_f32 v69, v69
    v_cvt_pk_bf16_f32 v49, v66, v67
    v_exp_f32 v70, v70
    ds_read_b64_tr_b16 a[14:15], v31 offset:2048
    ds_read_b64_tr_b16 a[16:17], v28 offset:4096
    v_mfma_f32_32x32x16_bf16 v[96:111], a[80:83], v[136:139], v[96:111]
    v_exp_f32 v71, v71
    v_cvt_pk_bf16_f32 v50, v68, v69
    ds_read_b64_tr_b16 a[18:19], v28 offset:6144
    ds_read_b64_tr_b16 a[20:21], v29 offset:4096
    ds_read_b64_tr_b16 a[22:23], v29 offset:6144
    s_waitcnt vmcnt(13)
    ds_write_b128 v11, a[224:227] offset:49152
    v_mfma_f32_32x32x16_bf16 v[112:127], a[84:87], v[136:139], v[112:127]
    v_cvt_pk_bf16_f32 v51, v70, v71
    v_exp_f32 v72, v72
    ds_read_b64_tr_b16 a[24:25], v30 offset:4096
    ds_read_b64_tr_b16 a[26:27], v30 offset:6144
    buffer_load_dwordx4 a[180:183], v8, s[28:31], s67 offen offset:1024 nt
    ds_write_b128 v11, a[228:231] offset:50176
    v_mfma_f32_32x32x16_bf16 v[96:111], a[88:91], v[140:143], v[96:111]
    v_exp_f32 v73, v73
    v_exp_f32 v74, v74
    ds_read_b64_tr_b16 a[28:29], v31 offset:4096
    ds_read_b64_tr_b16 a[30:31], v31 offset:6144
    ds_read_b64_tr_b16 a[32:33], v28 offset:8192
    ds_write_b128 v11, a[232:235] offset:51200
    v_mfma_f32_32x32x16_bf16 v[112:127], a[92:95], v[140:143], v[112:127]
    v_exp_f32 v75, v75
    v_cvt_pk_bf16_f32 v52, v72, v73
    v_exp_f32 v76, v76
    ds_read_b64_tr_b16 a[34:35], v28 offset:10240
    ds_read_b64_tr_b16 a[36:37], v29 offset:8192
    v_mfma_f32_32x32x16_bf16 v[96:111], a[96:99], v[144:147], v[96:111]
    v_exp_f32 v77, v77
    v_cvt_pk_bf16_f32 v53, v74, v75
    ds_read_b64_tr_b16 a[38:39], v29 offset:10240
    ds_read_b64_tr_b16 a[40:41], v30 offset:8192
    ds_read_b64_tr_b16 a[42:43], v30 offset:10240
    ds_write_b128 v11, a[236:239] offset:52224
    buffer_load_dwordx4 a[184:187], v8, s[28:31], s67 offen offset:2048 nt
    v_mfma_f32_32x32x16_bf16 v[112:127], a[100:103], v[144:147], v[112:127]
    v_exp_f32 v78, v78
    v_exp_f32 v79, v79
    ds_read_b64_tr_b16 a[44:45], v31 offset:8192
    ds_read_b64_tr_b16 a[46:47], v31 offset:10240
    ds_write_b128 v11, a[240:243] offset:53248
    v_mfma_f32_32x32x16_bf16 v[96:111], a[104:107], v[148:151], v[96:111]
    v_cvt_pk_bf16_f32 v54, v76, v77
    v_cvt_pk_bf16_f32 v55, v78, v79
    ds_read_b64_tr_b16 a[48:49], v28 offset:12288
    ds_read_b64_tr_b16 a[50:51], v28 offset:14336
    ds_read_b64_tr_b16 a[52:53], v29 offset:12288
    ds_write_b128 v11, a[244:247] offset:54272
    v_mfma_f32_32x32x16_bf16 v[112:127], a[108:111], v[148:151], v[112:127]
    v_exp_f32 v80, v80
    v_exp_f32 v81, v81
    v_exp_f32 v82, v82
    ds_read_b64_tr_b16 a[54:55], v29 offset:14336
    ds_read_b64_tr_b16 a[56:57], v30 offset:12288
    ds_write_b128 v11, a[248:251] offset:55296
    v_mfma_f32_32x32x16_bf16 v[96:111], a[112:115], v[152:155], v[96:111]
    v_exp_f32 v83, v83
    v_cvt_pk_bf16_f32 v56, v80, v81
    ds_read_b64_tr_b16 a[58:59], v30 offset:14336
    ds_read_b64_tr_b16 a[60:61], v31 offset:12288
    ds_read_b64_tr_b16 a[62:63], v31 offset:14336
    buffer_load_dwordx4 a[188:191], v8, s[28:31], s67 offen offset:3072 nt
    ds_write_b128 v11, a[252:255] offset:56320
    v_mfma_f32_32x32x16_bf16 v[112:127], a[116:119], v[152:155], v[112:127]
    v_exp_f32 v84, v84
    v_exp_f32 v85, v85
    v_mfma_f32_32x32x16_bf16 v[96:111], a[120:123], v[156:159], v[96:111]
    v_cvt_pk_bf16_f32 v57, v82, v83
    v_exp_f32 v86, v86
    v_mfma_f32_32x32x16_bf16 v[112:127], a[124:127], v[156:159], v[112:127]
    v_exp_f32 v87, v87
    v_cvt_pk_bf16_f32 v58, v84, v85
    v_cvt_pk_bf16_f32 v59, v86, v87
    s_waitcnt lgkmcnt(0)
    s_barrier
    v_mfma_f32_32x32x16_bf16 v[160:175], a[0:3], v[48:51], v[160:175]
    v_exp_f32 v88, v88
    v_exp_f32 v89, v89
    ds_read_b128 a[64:67], v20 offset:32768
    s_add_u32 s67, s49, 98304
    s_add_u32 m0, s57, 16384
    s_nop 0
    buffer_load_dwordx4 v4, s[24:27], s67 offen nt lds
    v_mfma_f32_32x32x16_bf16 v[176:191], a[4:7], v[48:51], v[176:191]
    v_exp_f32 v90, v90
    v_exp_f32 v91, v91
    v_cvt_pk_bf16_f32 v60, v88, v89
    ds_read_b128 a[68:71], v20 offset:40960
    v_mfma_f32_32x32x16_bf16 v[192:207], a[8:11], v[48:51], v[192:207]
    v_exp_f32 v92, v92
    v_exp_f32 v93, v93
    v_cvt_pk_bf16_f32 v61, v90, v91
    ds_read_b128 a[72:75], v21 offset:32768
    v_mfma_f32_32x32x16_bf16 v[208:223], a[12:15], v[48:51], v[208:223]
    v_exp_f32 v94, v94
    v_exp_f32 v95, v95
    v_cvt_pk_bf16_f32 v62, v92, v93
    ds_read_b128 a[76:79], v21 offset:40960
    buffer_load_dwordx4 v5, s[24:27], s67 offen offset:1024 nt lds
    v_mfma_f32_32x32x16_bf16 v[160:175], a[16:19], v[52:55], v[160:175]
    v_cvt_pk_bf16_f32 v63, v94, v95
    v_max3_f32 v32, v96, v97, v98
    v_max3_f32 v33, v112, v113, v114
    ds_read_b128 a[80:83], v22 offset:32768
    ds_read_b128 a[84:87], v22 offset:40960
    v_mfma_f32_32x32x16_bf16 v[176:191], a[20:23], v[52:55], v[176:191]
    v_max3_f32 v32, v32, v99, v100
    v_max3_f32 v33, v33, v115, v116
    v_max3_f32 v32, v32, v101, v102
    ds_read_b128 a[88:91], v23 offset:32768
    v_mfma_f32_32x32x16_bf16 v[192:207], a[24:27], v[52:55], v[192:207]
    v_max3_f32 v33, v33, v117, v118
    v_max3_f32 v32, v32, v103, v104
    v_max3_f32 v33, v33, v119, v120
    ds_read_b128 a[92:95], v23 offset:40960
    buffer_load_dwordx4 v6, s[24:27], s67 offen offset:2048 nt lds
    v_mfma_f32_32x32x16_bf16 v[208:223], a[28:31], v[52:55], v[208:223]
    v_max3_f32 v32, v32, v105, v106
    v_max3_f32 v33, v33, v121, v122
    v_max3_f32 v32, v32, v107, v108
    ds_read_b128 a[96:99], v24 offset:32768
    v_mfma_f32_32x32x16_bf16 v[160:175], a[32:35], v[56:59], v[160:175]
    v_max3_f32 v33, v33, v123, v124
    v_max3_f32 v32, v32, v109, v110
    v_max3_f32 v33, v33, v125, v126
    ds_read_b128 a[100:103], v24 offset:40960
    ds_read_b128 a[104:107], v25 offset:32768
    v_mfma_f32_32x32x16_bf16 v[176:191], a[36:39], v[56:59], v[176:191]
    v_max3_f32 v32, v32, v111, v127
    v_max_f32 v32, v32, v33
    v_pk_add_f32 v[224:225], v[224:225], v[64:65]
    ds_read_b128 a[108:111], v25 offset:40960
    buffer_load_dwordx4 v7, s[24:27], s67 offen offset:3072 nt lds
    v_mfma_f32_32x32x16_bf16 v[192:207], a[40:43], v[56:59], v[192:207]
    v_pk_add_f32 v[224:225], v[224:225], v[66:67]
    v_pk_add_f32 v[224:225], v[224:225], v[68:69]
    v_pk_add_f32 v[224:225], v[224:225], v[70:71]
    ds_read_b128 a[112:115], v26 offset:32768
    v_mfma_f32_32x32x16_bf16 v[208:223], a[44:47], v[56:59], v[208:223]
    v_pk_add_f32 v[224:225], v[224:225], v[72:73]
    v_pk_add_f32 v[224:225], v[224:225], v[74:75]
    v_pk_add_f32 v[224:225], v[224:225], v[76:77]
    ds_read_b128 a[116:119], v26 offset:40960
    v_mfma_f32_32x32x16_bf16 v[160:175], a[48:51], v[60:63], v[160:175]
    v_pk_add_f32 v[224:225], v[224:225], v[78:79]
    v_pk_add_f32 v[224:225], v[224:225], v[80:81]
    v_pk_add_f32 v[224:225], v[224:225], v[82:83]
    ds_read_b128 a[120:123], v27 offset:32768
    ds_read_b128 a[124:127], v27 offset:40960
    s_add_u32 s67, s49, 102400
    s_add_u32 m0, s57, 20480
    s_nop 0
    buffer_load_dwordx4 v4, s[24:27], s67 offen nt lds
    v_mfma_f32_32x32x16_bf16 v[176:191], a[52:55], v[60:63], v[176:191]
    v_pk_add_f32 v[224:225], v[224:225], v[84:85]
    v_pk_add_f32 v[224:225], v[224:225], v[86:87]
    v_pk_add_f32 v[224:225], v[224:225], v[88:89]
    v_mfma_f32_32x32x16_bf16 v[192:207], a[56:59], v[60:63], v[192:207]
    v_pk_add_f32 v[224:225], v[224:225], v[90:91]
    v_pk_add_f32 v[224:225], v[224:225], v[92:93]
    v_pk_add_f32 v[224:225], v[224:225], v[94:95]
    s_waitcnt vmcnt(13)
    ds_write_b128 v47, a[128:131] offset:0
    v_mfma_f32_32x32x16_bf16 v[208:223], a[60:63], v[60:63], v[208:223]
    ds_write_b128 v47, a[132:135] offset:1024
    buffer_load_dwordx4 v5, s[24:27], s67 offen offset:1024 nt lds
    v_cmp_lt_f32 vcc, 0x41000000, v32
    s_cbranch_vccz L_back3
    s_call_b64 s[72:73], L_rare1
L_back3:
    s_waitcnt lgkmcnt(0)
    s_barrier
    v_mfma_f32_32x32x16_bf16 v[64:79], a[64:67], v[128:131], v[240:255]
    v_exp_f32 v96, v96
    v_exp_f32 v97, v97
    ds_read_b64_tr_b16 a[0:1], v28 offset:32768
    ds_read_b64_tr_b16 a[2:3], v28 offset:34816
    ds_write_b128 v47, a[136:139] offset:2048
    v_mfma_f32_32x32x16_bf16 v[80:95], a[68:71], v[128:131], v[240:255]
    v_exp_f32 v98, v98
    v_exp_f32 v99, v99
    ds_read_b64_tr_b16 a[4:5], v29 offset:32768
    ds_read_b64_tr_b16 a[6:7], v29 offset:34816
    ds_write_b128 v47, a[140:143] offset:3072
    v_mfma_f32_32x32x16_bf16 v[64:79], a[72:75], v[132:135], v[64:79]
    v_cvt_pk_bf16_f32 v48, v96, v97
    v_exp_f32 v100, v100
    ds_read_b64_tr_b16 a[8:9], v30 offset:32768
    ds_read_b64_tr_b16 a[10:11], v30 offset:34816
    ds_read_b64_tr_b16 a[12:13], v31 offset:32768
    buffer_load_dwordx4 v6, s[24:27], s67 offen offset:2048 nt lds
    ds_write_b128 v47, a[144:147] offset:4096
    v_mfma_f32_32x32x16_bf16 v[80:95], a[76:79], v[132:135], v[80:95]
    v_exp_f32 v101, v101
    v_cvt_pk_bf16_f32 v49, v98, v99
    v_exp_f32 v102, v102
    ds_read_b64_tr_b16 a[14:15], v31 offset:34816
    ds_read_b64_tr_b16 a[16:17], v28 offset:36864
    ds_write_b128 v47, a[148:151] offset:5120
    v_mfma_f32_32x32x16_bf16 v[64:79], a[80:83], v[136:139], v[64:79]
    v_exp_f32 v103, v103
    v_cvt_pk_bf16_f32 v50, v100, v101
    ds_read_b64_tr_b16 a[18:19], v28 offset:38912
    ds_read_b64_tr_b16 a[20:21], v29 offset:36864
    ds_read_b64_tr_b16 a[22:23], v29 offset:38912
    v_mfma_f32_32x32x16_bf16 v[80:95], a[84:87], v[136:139], v[80:95]
    v_cvt_pk_bf16_f32 v51, v102, v103
    v_exp_f32 v104, v104
    ds_read_b64_tr_b16 a[24:25], v30 offset:36864
    ds_read_b64_tr_b16 a[26:27], v30 offset:38912
    ds_write_b128 v47, a[152:155] offset:6144
    buffer_load_dwordx4 v7, s[24:27], s67 offen offset:3072 nt lds
    v_mfma_f32_32x32x16_bf16 v[64:79], a[88:91], v[140:143], v[64:79]
    v_exp_f32 v105, v105
    v_exp_f32 v106, v106
    ds_read_b64_tr_b16 a[28:29], v31 offset:36864
    ds_read_b64_tr_b16 a[30:31], v31 offset:38912
    ds_read_b64_tr_b16 a[32:33], v28 offset:40960
    ds_write_b128 v47, a[156:159] offset:7168
    v_mfma_f32_32x32x16_bf16 v[80:95], a[92:95], v[140:143], v[80:95]
    v_exp_f32 v107, v107
    v_cvt_pk_bf16_f32 v52, v104, v105
    v_exp_f32 v108, v108
    ds_read_b64_tr_b16 a[34:35], v28 offset:43008
    ds_read_b64_tr_b16 a[36:37], v29 offset:40960
    v_mfma_f32_32x32x16_bf16 v[64:79], a[96:99], v[144:147], v[64:79]
    v_exp_f32 v109, v109
    v_cvt_pk_bf16_f32 v53, v106, v107
    ds_read_b64_tr_b16 a[38:39], v29 offset:43008
    ds_read_b64_tr_b16 a[40:41], v30 offset:40960
    ds_read_b64_tr_b16 a[42:43], v30 offset:43008
    s_add_u32 s67, s49, 81920
    s_add_u32 m0, s57, 32768
    s_nop 0
    buffer_load_dwordx4 v8, s[28:31], s67 offen nt lds
    v_mfma_f32_32x32x16_bf16 v[80:95], a[100:103], v[144:147], v[80:95]
    v_exp_f32 v110, v110
    v_exp_f32 v111, v111
    ds_read_b64_tr_b16 a[44:45], v31 offset:40960
    ds_read_b64_tr_b16 a[46:47], v31 offset:43008
    v_mfma_f32_32x32x16_bf16 v[64:79], a[104:107], v[148:151], v[64:79]
    v_cvt_pk_bf16_f32 v54, v108, v109
    v_cvt_pk_bf16_f32 v55, v110, v111
    ds_read_b64_tr_b16 a[48:49], v28 offset:45056
    ds_read_b64_tr_b16 a[50:51], v28 offset:47104
    ds_read_b64_tr_b16 a[52:53], v29 offset:45056
    v_mfma_f32_32x32x16_bf16 v[80:95], a[108:111], v[148:151], v[80:95]
    v_exp_f32 v112, v112
    v_exp_f32 v113, v113
    v_exp_f32 v114, v114
    ds_read_b64_tr_b16 a[54:55], v29 offset:47104
    ds_read_b64_tr_b16 a[56:57], v30 offset:45056
    buffer_load_dwordx4 v8, s[28:31], s67 offen offset:1024 nt lds
    v_mfma_f32_32x32x16_bf16 v[64:79], a[112:115], v[152:155], v[64:79]
    v_exp_f32 v115, v115
    v_cvt_pk_bf16_f32 v56, v112, v113
    ds_read_b64_tr_b16 a[58:59], v30 offset:47104
    ds_read_b64_tr_b16 a[60:61], v31 offset:45056
    ds_read_b64_tr_b16 a[62:63], v31 offset:47104
    v_mfma_f32_32x32x16_bf16 v[80:95], a[116:119], v[152:155], v[80:95]
    v_exp_f32 v116, v116
    v_exp_f32 v117, v117
    v_mfma_f32_32x32x16_bf16 v[64:79], a[120:123], v[156:159], v[64:79]
    v_cvt_pk_bf16_f32 v57, v114, v115
    v_exp_f32 v118, v118
    v_mfma_f32_32x32x16_bf16 v[80:95], a[124:127], v[156:159], v[80:95]
    v_exp_f32 v119, v119
    v_cvt_pk_bf16_f32 v58, v116, v117
    v_cvt_pk_bf16_f32 v59, v118, v119
    buffer_load_dwordx4 v8, s[28:31], s67 offen offset:2048 nt lds
    s_waitcnt lgkmcnt(0)
    s_barrier
    v_add_u32 v20, 0x4000, v20
    v_add_u32 v21, 0x4000, v21
    v_add_u32 v22, 0x4000, v22
    v_add_u32 v23, 0x4000, v23
    v_add_u32 v24, 0x4000, v24
    v_add_u32 v25, 0x4000, v25
    v_add_u32 v26, 0x4000, v26
    v_add_u32 v27, 0x4000, v27
    v_mfma_f32_32x32x16_bf16 v[160:175], a[0:3], v[48:51], v[160:175]
    v_exp_f32 v120, v120
    v_exp_f32 v121, v121
    ds_read_b128 a[64:67], v20 offset:49152
    v_mfma_f32_32x32x16_bf16 v[176:191], a[4:7], v[48:51], v[176:191]
    v_exp_f32 v122, v122
    v_exp_f32 v123, v123
    v_cvt_pk_bf16_f32 v60, v120, v121
    ds_read_b128 a[68:71], v20 offset:57344
    v_mfma_f32_32x32x16_bf16 v[192:207], a[8:11], v[48:51], v[192:207]
    v_exp_f32 v124, v124
    v_exp_f32 v125, v125
    v_cvt_pk_bf16_f32 v61, v122, v123
    ds_read_b128 a[72:75], v21 offset:49152
    buffer_load_dwordx4 v8, s[28:31], s67 offen offset:3072 nt lds
    v_mfma_f32_32x32x16_bf16 v[208:223], a[12:15], v[48:51], v[208:223]
    v_exp_f32 v126, v126
    v_exp_f32 v127, v127
    v_cvt_pk_bf16_f32 v62, v124, v125
    ds_read_b128 a[76:79], v21 offset:57344
    v_mfma_f32_32x32x16_bf16 v[160:175], a[16:19], v[52:55], v[160:175]
    v_cvt_pk_bf16_f32 v63, v126, v127
    v_max3_f32 v32, v64, v65, v66
    v_max3_f32 v33, v80, v81, v82
    ds_read_b128 a[80:83], v22 offset:49152
    ds_read_b128 a[84:87], v22 offset:57344
    v_mfma_f32_32x32x16_bf16 v[176:191], a[20:23], v[52:55], v[176:191]
    v_max3_f32 v32, v32, v67, v68
    v_max3_f32 v33, v33, v83, v84
    v_max3_f32 v32, v32, v69, v70
    ds_read_b128 a[88:91], v23 offset:49152
    s_add_u32 s67, s49, 86016
    s_add_u32 m0, s57, 36864
    s_nop 0
    buffer_load_dwordx4 v8, s[28:31], s67 offen nt lds
    s_waitcnt vmcnt(13)
    ds_write_b128 v11, a[160:163] offset:0
    v_mfma_f32_32x32x16_bf16 v[192:207], a[24:27], v[52:55], v[192:207]
    v_max3_f32 v33, v33, v85, v86
    v_max3_f32 v32, v32, v71, v72
    v_max3_f32 v33, v33, v87, v88
    ds_read_b128 a[92:95], v23 offset:57344
    ds_write_b128 v11, a[164:167] offset:1024
    v_mfma_f32_32x32x16_bf16 v[208:223], a[28:31], v[52:55], v[208:223]
    v_max3_f32 v32, v32, v73, v74
    v_max3_f32 v33, v33, v89, v90
    v_max3_f32 v32, v32, v75, v76
    ds_read_b128 a[96:99], v24 offset:49152
    v_mfma_f32_32x32x16_bf16 v[160:175], a[32:35], v[56:59], v[160:175]
    v_max3_f32 v33, v33, v91, v92
    v_max3_f32 v32, v32, v77, v78
    v_max3_f32 v33, v33, v93, v94
    ds_read_b128 a[100:103], v24 offset:57344
    ds_read_b128 a[104:107], v25 offset:49152
    s_lshl_b32 s47, s47, 18
    s_lshl_b32 s62, s52, 16
    s_add_u32 s47, s47, s62
    s_lshl_b32 s63, s3, 15
    s_lshl_b32 s60, s3, 11
    v_and_b32 v9, 7, v1
    v_lshlrev_b32 v10, 2, v41
    v_xor_b32 v9, v9, v10
    v_lshlrev_b32 v9, 4, v9
    v_lshrrev_b32 v10, 3, v1
    v_lshl_add_u32 v9, v10, 11, v9
    s_lshl_b32 s62, s55, 8
    s_add_u32 s66, s62, 128
    s_bitcmp1_b32 s52, 1
    s_cselect_b32 s74, s66, s62
    s_cselect_b32 s62, s62, s66
    v_add_u32 v10, s74, v9
    v_add_u32 v9, s62, v9
    s_mov_b32 s62, s55
    s_lshl_b32 s56, s62, 2
    s_add_u32 s56, s56, s52
    s_lshl_b32 s75, s56, 18
    s_add_u32 s75, s75, s63
    s_lshl_b32 s62, s54, 1
    s_add_u32 s62, s62, 0
    s_cmp_ge_u32 s62, 7
    s_cselect_b32 s66, 7, 0
    s_sub_u32 s62, s62, s66
    s_add_u32 s62, s62, 1
    s_add_u32 s62, s62, s55
    s_and_b32 s62, s62, 7
    s_lshl_b32 s11, s62, 13
    s_add_u32 s11, s11, s47
    s_lshl_b32 s56, s62, 2
    s_add_u32 s56, s56, s52
    s_lshl_b32 s4, s56, 18
    s_add_u32 s4, s4, s63
    s_lshl_b32 s62, s54, 1
    s_add_u32 s62, s62, 1
    s_cmp_ge_u32 s62, 7
    s_cselect_b32 s66, 7, 0
    s_sub_u32 s62, s62, s66
    s_add_u32 s62, s62, 1
    s_add_u32 s62, s62, s55
    s_and_b32 s62, s62, 7
    s_lshl_b32 s12, s62, 13
    s_add_u32 s12, s12, s47
    s_lshl_b32 s56, s62, 2
    s_add_u32 s56, s56, s52
    s_lshl_b32 s5, s56, 18
    s_add_u32 s5, s5, s63
    s_lshl_b32 s62, s54, 1
    s_add_u32 s62, s62, 2
    s_cmp_ge_u32 s62, 7
    s_cselect_b32 s66, 7, 0
    s_sub_u32 s62, s62, s66
    s_add_u32 s62, s62, 1
    s_add_u32 s62, s62, s55
    s_and_b32 s62, s62, 7
    s_lshl_b32 s13, s62, 13
    s_add_u32 s13, s13, s47
    s_lshl_b32 s56, s62, 2
    s_add_u32 s56, s56, s52
    s_lshl_b32 s6, s56, 18
    s_add_u32 s6, s6, s63
    s_lshl_b32 s62, s54, 1
    s_add_u32 s62, s62, 3
    s_cmp_ge_u32 s62, 7
    s_cselect_b32 s66, 7, 0
    s_sub_u32 s62, s62, s66
    s_add_u32 s62, s62, 1
    s_add_u32 s62, s62, s55
    s_and_b32 s62, s62, 7
    s_lshl_b32 s32, s62, 13
    s_add_u32 s32, s32, s47
    s_lshl_b32 s56, s62, 2
    s_add_u32 s56, s56, s52
    s_lshl_b32 s7, s56, 18
    s_add_u32 s7, s7, s63
    s_lshl_b32 s62, s54, 1
    s_add_u32 s62, s62, 4
    s_cmp_ge_u32 s62, 7
    s_cselect_b32 s66, 7, 0
    s_sub_u32 s62, s62, s66
    s_add_u32 s62, s62, 1
    s_add_u32 s62, s62, s55
    s_and_b32 s62, s62, 7
    s_lshl_b32 s33, s62, 13
    s_add_u32 s33, s33, s47
    s_lshl_b32 s56, s62, 2
    s_add_u32 s56, s56, s52
    s_lshl_b32 s8, s56, 18
    s_add_u32 s8, s8, s63
    s_lshl_b32 s62, s54, 1
    s_add_u32 s62, s62, 5
    s_cmp_ge_u32 s62, 7
    s_cselect_b32 s66, 7, 0
    s_sub_u32 s62, s62, s66
    s_add_u32 s62, s62, 1
    s_add_u32 s62, s62, s55
    s_and_b32 s62, s62, 7
    s_lshl_b32 s34, s62, 13
    s_add_u32 s34, s34, s47
    s_lshl_b32 s56, s62, 2
    s_add_u32 s56, s56, s52
    s_lshl_b32 s9, s56, 18
    s_add_u32 s9, s9, s63
    s_lshl_b32 s62, s54, 1
    s_add_u32 s62, s62, 6
    s_cmp_ge_u32 s62, 7
    s_cselect_b32 s66, 7, 0
    s_sub_u32 s62, s62, s66
    s_add_u32 s62, s62, 1
    s_add_u32 s62, s62, s55
    s_and_b32 s62, s62, 7
    s_lshl_b32 s35, s62, 13
    s_add_u32 s35, s35, s47
    s_lshl_b32 s56, s62, 2
    s_add_u32 s56, s56, s52
    s_lshl_b32 s10, s56, 18
    s_add_u32 s10, s10, s63
    ds_write_b128 v11, a[168:171] offset:2048
    v_mfma_f32_32x32x16_bf16 v[176:191], a[36:39], v[56:59], v[176:191]
    v_max3_f32 v32, v32, v79, v95
    v_max_f32 v32, v32, v33
    v_pk_add_f32 v[224:225], v[224:225], v[96:97]
    ds_read_b128 a[108:111], v25 offset:57344
    buffer_load_dwordx4 v8, s[28:31], s67 offen offset:1024 nt lds
    ds_write_b128 v11, a[172:175] offset:3072
    v_mfma_f32_32x32x16_bf16 v[192:207], a[40:43], v[56:59], v[192:207]
    v_pk_add_f32 v[224:225], v[224:225], v[98:99]
    v_pk_add_f32 v[224:225], v[224:225], v[100:101]
    v_pk_add_f32 v[224:225], v[224:225], v[102:103]
    ds_read_b128 a[112:115], v26 offset:49152
    ds_write_b128 v11, a[176:179] offset:4096
    v_mfma_f32_32x32x16_bf16 v[208:223], a[44:47], v[56:59], v[208:223]
    v_pk_add_f32 v[224:225], v[224:225], v[104:105]
    v_pk_add_f32 v[224:225], v[224:225], v[106:107]
    v_pk_add_f32 v[224:225], v[224:225], v[108:109]
    ds_read_b128 a[116:119], v26 offset:57344
    ds_write_b128 v11, a[180:183] offset:5120
    buffer_load_dwordx4 v8, s[28:31], s67 offen offset:2048 nt lds
    v_mfma_f32_32x32x16_bf16 v[160:175], a[48:51], v[60:63], v[160:175]
    v_pk_add_f32 v[224:225], v[224:225], v[110:111]
    v_pk_add_f32 v[224:225], v[224:225], v[112:113]
    v_pk_add_f32 v[224:225], v[224:225], v[114:115]
    ds_read_b128 a[120:123], v27 offset:49152
    ds_read_b128 a[124:127], v27 offset:57344
    ds_write_b128 v11, a[184:187] offset:6144
    v_mfma_f32_32x32x16_bf16 v[176:191], a[52:55], v[60:63], v[176:191]
    v_pk_add_f32 v[224:225], v[224:225], v[116:117]
    v_pk_add_f32 v[224:225], v[224:225], v[118:119]
    v_pk_add_f32 v[224:225], v[224:225], v[120:121]
    v_mfma_f32_32x32x16_bf16 v[192:207], a[56:59], v[60:63], v[192:207]
    v_pk_add_f32 v[224:225], v[224:225], v[122:123]
    v_pk_add_f32 v[224:225], v[224:225], v[124:125]
    v_pk_add_f32 v[224:225], v[224:225], v[126:127]
    ds_write_b128 v11, a[188:191] offset:7168
    buffer_load_dwordx4 v8, s[28:31], s67 offen offset:3072 nt lds
    v_mfma_f32_32x32x16_bf16 v[208:223], a[60:63], v[60:63], v[208:223]
    v_cmp_lt_f32 vcc, 0x41000000, v32
    s_cbranch_vccz L_back4
    s_call_b64 s[72:73], L_rare0
L_back4:
    global_load_dword v34, v0, s[16:17] sc1
    s_waitcnt lgkmcnt(0)
    s_barrier
    v_add_u32 v28, 0xffffc000, v28
    v_add_u32 v29, 0xffffc000, v29
    v_add_u32 v30, 0xffffc000, v30
    v_add_u32 v31, 0xffffc000, v31
    v_mfma_f32_32x32x16_bf16 v[96:111], a[64:67], v[128:131], v[240:255]
    v_exp_f32 v64, v64
    v_exp_f32 v65, v65
    ds_read_b64_tr_b16 a[0:1], v28 offset:0
    ds_read_b64_tr_b16 a[2:3], v28 offset:2048
    v_mfma_f32_32x32x16_bf16 v[112:127], a[68:71], v[128:131], v[240:255]
    v_exp_f32 v66, v66
    v_exp_f32 v67, v67
    ds_read_b64_tr_b16 a[4:5], v29 offset:0
    ds_read_b64_tr_b16 a[6:7], v29 offset:2048
    v_mfma_f32_32x32x16_bf16 v[96:111], a[72:75], v[132:135], v[96:111]
    v_cvt_pk_bf16_f32 v48, v64, v65
    v_exp_f32 v68, v68
    ds_read_b64_tr_b16 a[8:9], v30 offset:0
    ds_read_b64_tr_b16 a[10:11], v30 offset:2048
    ds_read_b64_tr_b16 a[12:13], v31 offset:0
    s_add_u32 s67, s49, 114688
    s_add_u32 m0, s57, 49152
    s_nop 0
    buffer_load_dwordx4 v4, s[24:27], s67 offen nt lds
    v_mfma_f32_32x32x16_bf16 v[112:127], a[76:79], v[132:135], v[112:127]
    v_exp_f32 v69, v69
    v_cvt_pk_bf16_f32 v49, v66, v67
    v_exp_f32 v70, v70
    ds_read_b64_tr_b16 a[14:15], v31 offset:2048
    ds_read_b64_tr_b16 a[16:17], v28 offset:4096
    v_mfma_f32_32x32x16_bf16 v[96:111], a[80:83], v[136:139], v[96:111]
    v_exp_f32 v71, v71
    v_cvt_pk_bf16_f32 v50, v68, v69
    ds_read_b64_tr_b16 a[18:19], v28 offset:6144
    ds_read_b64_tr_b16 a[20:21], v29 offset:4096
    ds_read_b64_tr_b16 a[22:23], v29 offset:6144
    v_mfma_f32_32x32x16_bf16 v[112:127], a[84:87], v[136:139], v[112:127]
    v_cvt_pk_bf16_f32 v51, v70, v71
    v_exp_f32 v72, v72
    ds_read_b64_tr_b16 a[24:25], v30 offset:4096
    ds_read_b64_tr_b16 a[26:27], v30 offset:6144
    buffer_load_dwordx4 v5, s[24:27], s67 offen offset:1024 nt lds
    v_mfma_f32_32x32x16_bf16 v[96:111], a[88:91], v[140:143], v[96:111]
    v_exp_f32 v73, v73
    v_exp_f32 v74, v74
    ds_read_b64_tr_b16 a[28:29], v31 offset:4096
    ds_read_b64_tr_b16 a[30:31], v31 offset:6144
    ds_read_b64_tr_b16 a[32:33], v28 offset:8192
    v_mfma_f32_32x32x16_bf16 v[112:127], a[92:95], v[140:143], v[112:127]
    v_exp_f32 v75, v75
    v_cvt_pk_bf16_f32 v52, v72, v73
    v_exp_f32 v76, v76
    ds_read_b64_tr_b16 a[34:35], v28 offset:10240
    ds_read_b64_tr_b16 a[36:37], v29 offset:8192
    v_mfma_f32_32x32x16_bf16 v[96:111], a[96:99], v[144:147], v[96:111]
    v_exp_f32 v77, v77
    v_cvt_pk_bf16_f32 v53, v74, v75
    ds_read_b64_tr_b16 a[38:39], v29 offset:10240
    ds_read_b64_tr_b16 a[40:41], v30 offset:8192
    ds_read_b64_tr_b16 a[42:43], v30 offset:10240
    buffer_load_dwordx4 v6, s[24:27], s67 offen offset:2048 nt lds
    v_mfma_f32_32x32x16_bf16 v[112:127], a[100:103], v[144:147], v[112:127]
    v_exp_f32 v78, v78
    v_exp_f32 v79, v79
    ds_read_b64_tr_b16 a[44:45], v31 offset:8192
    ds_read_b64_tr_b16 a[46:47], v31 offset:10240
    v_mfma_f32_32x32x16_bf16 v[96:111], a[104:107], v[148:151], v[96:111]
    v_cvt_pk_bf16_f32 v54, v76, v77
    v_cvt_pk_bf16_f32 v55, v78, v79
    ds_read_b64_tr_b16 a[48:49], v28 offset:12288
    ds_read_b64_tr_b16 a[50:51], v28 offset:14336
    ds_read_b64_tr_b16 a[52:53], v29 offset:12288
    v_mfma_f32_32x32x16_bf16 v[112:127], a[108:111], v[148:151], v[112:127]
    v_exp_f32 v80, v80
    v_exp_f32 v81, v81
    v_exp_f32 v82, v82
    ds_read_b64_tr_b16 a[54:55], v29 offset:14336
    ds_read_b64_tr_b16 a[56:57], v30 offset:12288
    buffer_load_dwordx4 v7, s[24:27], s67 offen offset:3072 nt lds
    v_mfma_f32_32x32x16_bf16 v[96:111], a[112:115], v[152:155], v[96:111]
    v_exp_f32 v83, v83
    v_cvt_pk_bf16_f32 v56, v80, v81
    ds_read_b64_tr_b16 a[58:59], v30 offset:14336
    ds_read_b64_tr_b16 a[60:61], v31 offset:12288
    ds_read_b64_tr_b16 a[62:63], v31 offset:14336
    v_mfma_f32_32x32x16_bf16 v[112:127], a[116:119], v[152:155], v[112:127]
    v_exp_f32 v84, v84
    v_exp_f32 v85, v85
    v_mfma_f32_32x32x16_bf16 v[96:111], a[120:123], v[156:159], v[96:111]
    v_cvt_pk_bf16_f32 v57, v82, v83
    v_exp_f32 v86, v86
    s_add_u32 s67, s49, 118784
    s_add_u32 m0, s57, 53248
    s_nop 0
    buffer_load_dwordx4 v4, s[24:27], s67 offen nt lds
    v_mfma_f32_32x32x16_bf16 v[112:127], a[124:127], v[156:159], v[112:127]
    v_exp_f32 v87, v87
    v_cvt_pk_bf16_f32 v58, v84, v85
    v_cvt_pk_bf16_f32 v59, v86, v87
    s_waitcnt vmcnt(14) lgkmcnt(0)
    s_barrier
    v_mfma_f32_32x32x16_bf16 v[160:175], a[0:3], v[48:51], v[160:175]
    v_exp_f32 v88, v88
    v_exp_f32 v89, v89
    ds_read_b128 a[64:67], v20 offset:0
    v_mfma_f32_32x32x16_bf16 v[176:191], a[4:7], v[48:51], v[176:191]
    v_exp_f32 v90, v90
    v_exp_f32 v91, v91
    v_cvt_pk_bf16_f32 v60, v88, v89
    ds_read_b128 a[68:71], v20 offset:8192
    v_mfma_f32_32x32x16_bf16 v[192:207], a[8:11], v[48:51], v[192:207]
    v_exp_f32 v92, v92
    v_exp_f32 v93, v93
    v_cvt_pk_bf16_f32 v61, v90, v91
    ds_read_b128 a[72:75], v21 offset:0
    buffer_load_dwordx4 v5, s[24:27], s67 offen offset:1024 nt lds
    v_mfma_f32_32x32x16_bf16 v[208:223], a[12:15], v[48:51], v[208:223]
    v_exp_f32 v94, v94
    v_exp_f32 v95, v95
    v_cvt_pk_bf16_f32 v62, v92, v93
    ds_read_b128 a[76:79], v21 offset:8192
    v_mfma_f32_32x32x16_bf16 v[160:175], a[16:19], v[52:55], v[160:175]
    v_cvt_pk_bf16_f32 v63, v94, v95
    v_max3_f32 v32, v96, v97, v98
    v_max3_f32 v33, v112, v113, v114
    ds_read_b128 a[80:83], v22 offset:0
    ds_read_b128 a[84:87], v22 offset:8192
    v_mfma_f32_32x32x16_bf16 v[176:191], a[20:23], v[52:55], v[176:191]
    v_max3_f32 v32, v32, v99, v100
    v_max3_f32 v33, v33, v115, v116
    v_max3_f32 v32, v32, v101, v102
    ds_read_b128 a[88:91], v23 offset:0
    buffer_load_dwordx4 v6, s[24:27], s67 offen offset:2048 nt lds
    v_mfma_f32_32x32x16_bf16 v[192:207], a[24:27], v[52:55], v[192:207]
    v_max3_f32 v33, v33, v117, v118
    v_max3_f32 v32, v32, v103, v104
    v_max3_f32 v33, v33, v119, v120
    ds_read_b128 a[92:95], v23 offset:8192
    v_mfma_f32_32x32x16_bf16 v[208:223], a[28:31], v[52:55], v[208:223]
    v_max3_f32 v32, v32, v105, v106
    v_max3_f32 v33, v33, v121, v122
    v_max3_f32 v32, v32, v107, v108
    ds_read_b128 a[96:99], v24 offset:0
    v_mfma_f32_32x32x16_bf16 v[160:175], a[32:35], v[56:59], v[160:175]
    v_max3_f32 v33, v33, v123, v124
    v_max3_f32 v32, v32, v109, v110
    v_max3_f32 v33, v33, v125, v126
    ds_read_b128 a[100:103], v24 offset:8192
    ds_read_b128 a[104:107], v25 offset:0
    buffer_load_dwordx4 v7, s[24:27], s67 offen offset:3072 nt lds
    v_mfma_f32_32x32x16_bf16 v[176:191], a[36:39], v[56:59], v[176:191]
    v_max3_f32 v32, v32, v111, v127
    v_max_f32 v32, v32, v33
    v_pk_add_f32 v[224:225], v[224:225], v[64:65]
    ds_read_b128 a[108:111], v25 offset:8192
    v_mfma_f32_32x32x16_bf16 v[192:207], a[40:43], v[56:59], v[192:207]
    v_pk_add_f32 v[224:225], v[224:225], v[66:67]
    v_pk_add_f32 v[224:225], v[224:225], v[68:69]
    v_pk_add_f32 v[224:225], v[224:225], v[70:71]
    ds_read_b128 a[112:115], v26 offset:0
    v_mfma_f32_32x32x16_bf16 v[208:223], a[44:47], v[56:59], v[208:223]
    v_pk_add_f32 v[224:225], v[224:225], v[72:73]
    v_pk_add_f32 v[224:225], v[224:225], v[74:75]
    v_pk_add_f32 v[224:225], v[224:225], v[76:77]
    ds_read_b128 a[116:119], v26 offset:8192
    s_add_u32 s67, s49, 98304
    s_add_u32 m0, s57, 65536
    s_nop 0
    buffer_load_dwordx4 v8, s[28:31], s67 offen nt lds
    v_mfma_f32_32x32x16_bf16 v[160:175], a[48:51], v[60:63], v[160:175]
    v_pk_add_f32 v[224:225], v[224:225], v[78:79]
    v_pk_add_f32 v[224:225], v[224:225], v[80:81]
    v_pk_add_f32 v[224:225], v[224:225], v[82:83]
    ds_read_b128 a[120:123], v27 offset:0
    ds_read_b128 a[124:127], v27 offset:8192
    v_mfma_f32_32x32x16_bf16 v[176:191], a[52:55], v[60:63], v[176:191]
    v_pk_add_f32 v[224:225], v[224:225], v[84:85]
    v_pk_add_f32 v[224:225], v[224:225], v[86:87]
    v_pk_add_f32 v[224:225], v[224:225], v[88:89]
    v_mfma_f32_32x32x16_bf16 v[192:207], a[56:59], v[60:63], v[192:207]
    v_pk_add_f32 v[224:225], v[224:225], v[90:91]
    v_pk_add_f32 v[224:225], v[224:225], v[92:93]
    v_pk_add_f32 v[224:225], v[224:225], v[94:95]
    buffer_load_dwordx4 v8, s[28:31], s67 offen offset:1024 nt lds
    v_mfma_f32_32x32x16_bf16 v[208:223], a[60:63], v[60:63], v[208:223]
    v_cmp_lt_f32 vcc, 0x41000000, v32
    s_cbranch_vccz L_back5
    s_call_b64 s[72:73], L_rare1
L_back5:
    s_waitcnt vmcnt(11) lgkmcnt(0)
    s_barrier
    v_mfma_f32_32x32x16_bf16 v[64:79], a[64:67], v[128:131], v[240:255]
    v_exp_f32 v96, v96
    v_exp_f32 v97, v97
    ds_read_b64_tr_b16 a[0:1], v28 offset:32768
    ds_read_b64_tr_b16 a[2:3], v28 offset:34816
    v_mfma_f32_32x32x16_bf16 v[80:95], a[68:71], v[128:131], v[240:255]
    v_exp_f32 v98, v98
    v_exp_f32 v99, v99
    ds_read_b64_tr_b16 a[4:5], v29 offset:32768
    ds_read_b64_tr_b16 a[6:7], v29 offset:34816
    buffer_load_dwordx4 v8, s[28:31], s67 offen offset:2048 nt lds
    v_mfma_f32_32x32x16_bf16 v[64:79], a[72:75], v[132:135], v[64:79]
    v_cvt_pk_bf16_f32 v48, v96, v97
    v_exp_f32 v100, v100
    ds_read_b64_tr_b16 a[8:9], v30 offset:32768
    ds_read_b64_tr_b16 a[10:11], v30 offset:34816
    ds_read_b64_tr_b16 a[12:13], v31 offset:32768
    v_mfma_f32_32x32x16_bf16 v[80:95], a[76:79], v[132:135], v[80:95]
    v_exp_f32 v101, v101
    v_cvt_pk_bf16_f32 v49, v98, v99
    v_exp_f32 v102, v102
    ds_read_b64_tr_b16 a[14:15], v31 offset:34816
    ds_read_b64_tr_b16 a[16:17], v28 offset:36864
    v_mfma_f32_32x32x16_bf16 v[64:79], a[80:83], v[136:139], v[64:79]
    v_exp_f32 v103, v103
    v_cvt_pk_bf16_f32 v50, v100, v101
    ds_read_b64_tr_b16 a[18:19], v28 offset:38912
    ds_read_b64_tr_b16 a[20:21], v29 offset:36864
    ds_read_b64_tr_b16 a[22:23], v29 offset:38912
    v_mfma_f32_32x32x16_bf16 v[80:95], a[84:87], v[136:139], v[80:95]
    v_cvt_pk_bf16_f32 v51, v102, v103
    v_exp_f32 v104, v104
    ds_read_b64_tr_b16 a[24:25], v30 offset:36864
    ds_read_b64_tr_b16 a[26:27], v30 offset:38912
    buffer_load_dwordx4 v8, s[28:31], s67 offen offset:3072 nt lds
    v_mfma_f32_32x32x16_bf16 v[64:79], a[88:91], v[140:143], v[64:79]
    v_exp_f32 v105, v105
    v_exp_f32 v106, v106
    ds_read_b64_tr_b16 a[28:29], v31 offset:36864
    ds_read_b64_tr_b16 a[30:31], v31 offset:38912
    ds_read_b64_tr_b16 a[32:33], v28 offset:40960
    v_mfma_f32_32x32x16_bf16 v[80:95], a[92:95], v[140:143], v[80:95]
    v_exp_f32 v107, v107
    v_cvt_pk_bf16_f32 v52, v104, v105
    v_exp_f32 v108, v108
    ds_read_b64_tr_b16 a[34:35], v28 offset:43008
    ds_read_b64_tr_b16 a[36:37], v29 offset:40960
    v_mfma_f32_32x32x16_bf16 v[64:79], a[96:99], v[144:147], v[64:79]
    v_exp_f32 v109, v109
    v_cvt_pk_bf16_f32 v53, v106, v107
    ds_read_b64_tr_b16 a[38:39], v29 offset:43008
    ds_read_b64_tr_b16 a[40:41], v30 offset:40960
    ds_read_b64_tr_b16 a[42:43], v30 offset:43008
    s_add_u32 s67, s49, 102400
    s_add_u32 m0, s57, 69632
    s_nop 0
    buffer_load_dwordx4 v8, s[28:31], s67 offen nt lds
    v_mfma_f32_32x32x16_bf16 v[80:95], a[100:103], v[144:147], v[80:95]
    v_exp_f32 v110, v110
    v_exp_f32 v111, v111
    ds_read_b64_tr_b16 a[44:45], v31 offset:40960
    ds_read_b64_tr_b16 a[46:47], v31 offset:43008
    v_mfma_f32_32x32x16_bf16 v[64:79], a[104:107], v[148:151], v[64:79]
    v_cvt_pk_bf16_f32 v54, v108, v109
    v_cvt_pk_bf16_f32 v55, v110, v111
    ds_read_b64_tr_b16 a[48:49], v28 offset:45056
    ds_read_b64_tr_b16 a[50:51], v28 offset:47104
    ds_read_b64_tr_b16 a[52:53], v29 offset:45056
    v_mfma_f32_32x32x16_bf16 v[80:95], a[108:111], v[148:151], v[80:95]
    v_exp_f32 v112, v112
    v_exp_f32 v113, v113
    v_exp_f32 v114, v114
    ds_read_b64_tr_b16 a[54:55], v29 offset:47104
    ds_read_b64_tr_b16 a[56:57], v30 offset:45056
    buffer_load_dwordx4 v8, s[28:31], s67 offen offset:1024 nt lds
    v_mfma_f32_32x32x16_bf16 v[64:79], a[112:115], v[152:155], v[64:79]
    v_exp_f32 v115, v115
    v_cvt_pk_bf16_f32 v56, v112, v113
    ds_read_b64_tr_b16 a[58:59], v30 offset:47104
    ds_read_b64_tr_b16 a[60:61], v31 offset:45056
    ds_read_b64_tr_b16 a[62:63], v31 offset:47104
    v_mfma_f32_32x32x16_bf16 v[80:95], a[116:119], v[152:155], v[80:95]
    v_exp_f32 v116, v116
    v_exp_f32 v117, v117
    v_mfma_f32_32x32x16_bf16 v[64:79], a[120:123], v[156:159], v[64:79]
    v_cvt_pk_bf16_f32 v57, v114, v115
    v_exp_f32 v118, v118
    buffer_load_dwordx4 v8, s[28:31], s67 offen offset:2048 nt lds
    v_mfma_f32_32x32x16_bf16 v[80:95], a[124:127], v[156:159], v[80:95]
    v_exp_f32 v119, v119
    v_cvt_pk_bf16_f32 v58, v116, v117
    v_cvt_pk_bf16_f32 v59, v118, v119
    s_waitcnt vmcnt(7) lgkmcnt(0)
    s_barrier
    v_mfma_f32_32x32x16_bf16 v[160:175], a[0:3], v[48:51], v[160:175]
    v_exp_f32 v120, v120
    v_exp_f32 v121, v121
    ds_read_b128 a[64:67], v20 offset:32768
    v_mfma_f32_32x32x16_bf16 v[176:191], a[4:7], v[48:51], v[176:191]
    v_exp_f32 v122, v122
    v_exp_f32 v123, v123
    v_cvt_pk_bf16_f32 v60, v120, v121
    ds_read_b128 a[68:71], v20 offset:40960
    buffer_load_dwordx4 v8, s[28:31], s67 offen offset:3072 nt lds
    v_mfma_f32_32x32x16_bf16 v[192:207], a[8:11], v[48:51], v[192:207]
    v_exp_f32 v124, v124
    v_exp_f32 v125, v125
    v_cvt_pk_bf16_f32 v61, v122, v123
    ds_read_b128 a[72:75], v21 offset:32768
    v_mfma_f32_32x32x16_bf16 v[208:223], a[12:15], v[48:51], v[208:223]
    v_exp_f32 v126, v126
    v_exp_f32 v127, v127
    v_cvt_pk_bf16_f32 v62, v124, v125
    ds_read_b128 a[76:79], v21 offset:40960
    v_mfma_f32_32x32x16_bf16 v[160:175], a[16:19], v[52:55], v[160:175]
    v_cvt_pk_bf16_f32 v63, v126, v127
    v_max3_f32 v32, v64, v65, v66
    v_max3_f32 v33, v80, v81, v82
    ds_read_b128 a[80:83], v22 offset:32768
    ds_read_b128 a[84:87], v22 offset:40960
    s_add_u32 s67, s49, 114688
    s_add_u32 m0, s57, 0
    s_nop 0
    buffer_load_dwordx4 v8, s[28:31], s67 offen nt lds
    v_mfma_f32_32x32x16_bf16 v[176:191], a[20:23], v[52:55], v[176:191]
    v_max3_f32 v32, v32, v67, v68
    v_max3_f32 v33, v33, v83, v84
    v_max3_f32 v32, v32, v69, v70
    ds_read_b128 a[88:91], v23 offset:32768
    v_mfma_f32_32x32x16_bf16 v[192:207], a[24:27], v[52:55], v[192:207]
    v_max3_f32 v33, v33, v85, v86
    v_max3_f32 v32, v32, v71, v72
    v_max3_f32 v33, v33, v87, v88
    ds_read_b128 a[92:95], v23 offset:40960
    v_mfma_f32_32x32x16_bf16 v[208:223], a[28:31], v[52:55], v[208:223]
    v_max3_f32 v32, v32, v73, v74
    v_max3_f32 v33, v33, v89, v90
    v_max3_f32 v32, v32, v75, v76
    ds_read_b128 a[96:99], v24 offset:32768
    v_mfma_f32_32x32x16_bf16 v[160:175], a[32:35], v[56:59], v[160:175]
    v_max3_f32 v33, v33, v91, v92
    v_max3_f32 v32, v32, v77, v78
    v_max3_f32 v33, v33, v93, v94
    ds_read_b128 a[100:103], v24 offset:40960
    ds_read_b128 a[104:107], v25 offset:32768
    buffer_load_dwordx4 v8, s[28:31], s67 offen offset:1024 nt lds
    v_mfma_f32_32x32x16_bf16 v[176:191], a[36:39], v[56:59], v[176:191]
    v_max3_f32 v32, v32, v79, v95
    v_max_f32 v32, v32, v33
    v_pk_add_f32 v[224:225], v[224:225], v[96:97]
    ds_read_b128 a[108:111], v25 offset:40960
    v_mfma_f32_32x32x16_bf16 v[192:207], a[40:43], v[56:59], v[192:207]
    v_pk_add_f32 v[224:225], v[224:225], v[98:99]
    v_pk_add_f32 v[224:225], v[224:225], v[100:101]
    v_pk_add_f32 v[224:225], v[224:225], v[102:103]
    ds_read_b128 a[112:115], v26 offset:32768
    v_mfma_f32_32x32x16_bf16 v[208:223], a[44:47], v[56:59], v[208:223]
    v_pk_add_f32 v[224:225], v[224:225], v[104:105]
    v_pk_add_f32 v[224:225], v[224:225], v[106:107]
    v_pk_add_f32 v[224:225], v[224:225], v[108:109]
    ds_read_b128 a[116:119], v26 offset:40960
    buffer_load_dwordx4 v8, s[28:31], s67 offen offset:2048 nt lds
    v_mfma_f32_32x32x16_bf16 v[160:175], a[48:51], v[60:63], v[160:175]
    v_pk_add_f32 v[224:225], v[224:225], v[110:111]
    v_pk_add_f32 v[224:225], v[224:225], v[112:113]
    v_pk_add_f32 v[224:225], v[224:225], v[114:115]
    ds_read_b128 a[120:123], v27 offset:32768
    ds_read_b128 a[124:127], v27 offset:40960
    v_mfma_f32_32x32x16_bf16 v[176:191], a[52:55], v[60:63], v[176:191]
    v_pk_add_f32 v[224:225], v[224:225], v[116:117]
    v_pk_add_f32 v[224:225], v[224:225], v[118:119]
    v_pk_add_f32 v[224:225], v[224:225], v[120:121]
    v_mfma_f32_32x32x16_bf16 v[192:207], a[56:59], v[60:63], v[192:207]
    v_pk_add_f32 v[224:225], v[224:225], v[122:123]
    v_pk_add_f32 v[224:225], v[224:225], v[124:125]
    v_pk_add_f32 v[224:225], v[224:225], v[126:127]
    buffer_load_dwordx4 v8, s[28:31], s67 offen offset:3072 nt lds
    v_mfma_f32_32x32x16_bf16 v[208:223], a[60:63], v[60:63], v[208:223]
    v_cmp_lt_f32 vcc, 0x41000000, v32
    s_cbranch_vccz L_back6
    s_call_b64 s[72:73], L_rare0
L_back6:
    s_waitcnt lgkmcnt(15)
    v_mfma_f32_32x32x16_bf16 v[96:111], a[64:67], v[128:131], v[240:255]
    v_exp_f32 v64, v64
    v_exp_f32 v65, v65
    s_waitcnt lgkmcnt(14)
    v_mfma_f32_32x32x16_bf16 v[112:127], a[68:71], v[128:131], v[240:255]
    v_exp_f32 v66, v66
    v_exp_f32 v67, v67
    s_add_u32 s67, s49, 118784
    s_add_u32 m0, s57, 4096
    s_nop 0
    buffer_load_dwordx4 v8, s[28:31], s67 offen nt lds
    s_waitcnt lgkmcnt(13)
    v_mfma_f32_32x32x16_bf16 v[96:111], a[72:75], v[132:135], v[96:111]
    v_cvt_pk_bf16_f32 v48, v64, v65
    v_exp_f32 v68, v68
    s_waitcnt lgkmcnt(12)
    v_mfma_f32_32x32x16_bf16 v[112:127], a[76:79], v[132:135], v[112:127]
    v_exp_f32 v69, v69
    v_cvt_pk_bf16_f32 v49, v66, v67
    v_exp_f32 v70, v70
    s_waitcnt lgkmcnt(11)
    v_mfma_f32_32x32x16_bf16 v[96:111], a[80:83], v[136:139], v[96:111]
    v_exp_f32 v71, v71
    v_cvt_pk_bf16_f32 v50, v68, v69
    buffer_load_dwordx4 v8, s[28:31], s67 offen offset:1024 nt lds
    s_waitcnt lgkmcnt(10)
    v_mfma_f32_32x32x16_bf16 v[112:127], a[84:87], v[136:139], v[112:127]
    v_cvt_pk_bf16_f32 v51, v70, v71
    v_exp_f32 v72, v72
    s_waitcnt lgkmcnt(9)
    v_mfma_f32_32x32x16_bf16 v[96:111], a[88:91], v[140:143], v[96:111]
    v_exp_f32 v73, v73
    v_exp_f32 v74, v74
    s_waitcnt lgkmcnt(8)
    v_mfma_f32_32x32x16_bf16 v[112:127], a[92:95], v[140:143], v[112:127]
    v_exp_f32 v75, v75
    v_cvt_pk_bf16_f32 v52, v72, v73
    v_exp_f32 v76, v76
    s_waitcnt lgkmcnt(7)
    v_mfma_f32_32x32x16_bf16 v[96:111], a[96:99], v[144:147], v[96:111]
    v_exp_f32 v77, v77
    v_cvt_pk_bf16_f32 v53, v74, v75
    buffer_load_dwordx4 v8, s[28:31], s67 offen offset:2048 nt lds
    s_waitcnt lgkmcnt(6)
    v_mfma_f32_32x32x16_bf16 v[112:127], a[100:103], v[144:147], v[112:127]
    v_exp_f32 v78, v78
    v_exp_f32 v79, v79
    s_waitcnt lgkmcnt(5)
    v_mfma_f32_32x32x16_bf16 v[96:111], a[104:107], v[148:151], v[96:111]
    v_cvt_pk_bf16_f32 v54, v76, v77
    v_cvt_pk_bf16_f32 v55, v78, v79
    s_waitcnt lgkmcnt(4)
    v_mfma_f32_32x32x16_bf16 v[112:127], a[108:111], v[148:151], v[112:127]
    v_exp_f32 v80, v80
    v_exp_f32 v81, v81
    v_exp_f32 v82, v82
    buffer_load_dwordx4 v8, s[28:31], s67 offen offset:3072 nt lds
    s_waitcnt lgkmcnt(3)
    v_mfma_f32_32x32x16_bf16 v[96:111], a[112:115], v[152:155], v[96:111]
    v_exp_f32 v83, v83
    v_cvt_pk_bf16_f32 v56, v80, v81
    s_waitcnt lgkmcnt(2)
    v_mfma_f32_32x32x16_bf16 v[112:127], a[116:119], v[152:155], v[112:127]
    v_exp_f32 v84, v84
    v_exp_f32 v85, v85
    s_waitcnt lgkmcnt(1)
    v_mfma_f32_32x32x16_bf16 v[96:111], a[120:123], v[156:159], v[96:111]
    v_cvt_pk_bf16_f32 v57, v82, v83
    v_exp_f32 v86, v86
    s_waitcnt lgkmcnt(0)
    v_mfma_f32_32x32x16_bf16 v[112:127], a[124:127], v[156:159], v[112:127]
    v_exp_f32 v87, v87
    v_cvt_pk_bf16_f32 v58, v84, v85
    v_cvt_pk_bf16_f32 v59, v86, v87
    s_mov_b32 s71, 0
L_nonce:
    v_readfirstlane_b32 s70, v34
    v_readlane_b32 s68, v34, 1
    s_cmp_lg_u32 s70, 0
    s_cbranch_scc1 L_nonce_ok
    global_load_dword v34, v0, s[16:17] sc1
    s_waitcnt vmcnt(0)
    s_add_u32 s71, s71, 1
    s_cmp_lt_u32 s71, 65536
    s_cbranch_scc1 L_nonce
L_nonce_ok:
    s_lshr_b32 s68, s68, s69
    s_and_b32 s68, s68, 15
    s_lshl_b32 s62, s55, 13
    s_add_u32 s44, s47, s62
    s_add_u32 s46, s44, 4096
    v_lshlrev_b32 v11, 4, v1
    v_lshl_add_u32 v21, v40, 2, v42
    v_lshlrev_b32 v21, 7, v21
    v_lshl_add_u32 v21, v41, 5, v21
    v_lshl_add_u32 v21, v35, 3, v21
    v_lshrrev_b32 v22, 1, v42
    s_and_b32 s62, s52, 1
    v_xor_b32 v22, s62, v22
    v_lshl_add_u32 v12, v22, 6, v21
    v_xor_b32 v13, 64, v12
    v_add_u32 v14, 65536, v12
    v_add_u32 v15, 65536, v13
    v_add_u32 v16, 131072, v12
    v_add_u32 v17, 131072, v13
    s_lshl_b32 s48, s45, 2
    s_add_u32 s48, s48, s52
    s_lshl_b32 s48, s48, 2
    s_add_u32 s48, s48, s3
    s_lshl_b32 s48, s48, 7
    s_add_u32 s48, s48, 41943040
    s_lshl_b32 s62, s55, 2
    v_mov_b32 v34, s62
    v_mov_b32 v35, s70
    v_and_b32 v36, 7, v1
    v_lshlrev_b32 v36, 2, v36
    s_mov_b32 s20, s14
    s_mov_b32 s21, s15
    s_mov_b32 s22, 2097152
    s_mov_b32 s23, 0x20000
    s_lshl_b32 s62, s45, 3
    s_add_u32 s62, s62, s55
    s_lshl_b32 s64, s62, 18
    s_add_u32 s64, s64, 8388608
    s_add_u32 s64, s64, s61
    s_lshl_b32 s62, s52, 16
    s_add_u32 s65, s64, s62
    s_lshl_b32 s58, s45, 2
    s_add_u32 s58, s58, s3
    s_lshl_b32 s58, s58, 16
    s_add_u32 s58, s58, s74
    s_and_b32 s62, s52, 1
    s_lshl_b32 s62, s62, 6
    s_add_u32 s58, s58, s62
    v_lshlrev_b32 v21, 11, v46
    v_lshl_add_u32 v21, v40, 4, v21
    v_min_u32 v39, 2, v1
    v_lshlrev_b32 v39, 14, v39
    v_add_u32 v39, 19452, v39
    s_waitcnt vmcnt(8)
    s_barrier
    v_add_u32 v28, 0x4000, v28
    v_add_u32 v29, 0x4000, v29
    v_add_u32 v30, 0x4000, v30
    v_add_u32 v31, 0x4000, v31
    s_add_u32 m0, s60, 16384
    s_nop 0
    buffer_load_dwordx4 v9, s[40:43], s75 offen lds
    ds_read_b64_tr_b16 a[0:1], v28 offset:49152
    ds_read_b64_tr_b16 a[2:3], v28 offset:51200
    ds_read_b64_tr_b16 a[4:5], v29 offset:49152
    ds_read_b64_tr_b16 a[6:7], v29 offset:51200
    ds_read_b64_tr_b16 a[8:9], v30 offset:49152
    ds_read_b64_tr_b16 a[10:11], v30 offset:51200
    ds_read_b64_tr_b16 a[12:13], v31 offset:49152
    ds_read_b64_tr_b16 a[14:15], v31 offset:51200
    ds_read_b64_tr_b16 a[16:17], v28 offset:53248
    ds_read_b64_tr_b16 a[18:19], v28 offset:55296
    ds_read_b64_tr_b16 a[20:21], v29 offset:53248
    ds_read_b64_tr_b16 a[22:23], v29 offset:55296
    ds_read_b64_tr_b16 a[24:25], v30 offset:53248
    ds_read_b64_tr_b16 a[26:27], v30 offset:55296
    ds_read_b64_tr_b16 a[28:29], v31 offset:53248
    ds_read_b64_tr_b16 a[30:31], v31 offset:55296
    ds_read_b64_tr_b16 a[32:33], v28 offset:57344
    ds_read_b64_tr_b16 a[34:35], v28 offset:59392
    ds_read_b64_tr_b16 a[36:37], v29 offset:57344
    ds_read_b64_tr_b16 a[38:39], v29 offset:59392
    ds_read_b64_tr_b16 a[40:41], v30 offset:57344
    ds_read_b64_tr_b16 a[42:43], v30 offset:59392
    ds_read_b64_tr_b16 a[44:45], v31 offset:57344
    ds_read_b64_tr_b16 a[46:47], v31 offset:59392
    ds_read_b64_tr_b16 a[48:49], v28 offset:61440
    ds_read_b64_tr_b16 a[50:51], v28 offset:63488
    ds_read_b64_tr_b16 a[52:53], v29 offset:61440
    ds_read_b64_tr_b16 a[54:55], v29 offset:63488
    ds_read_b64_tr_b16 a[56:57], v30 offset:61440
    ds_read_b64_tr_b16 a[58:59], v30 offset:63488
    ds_read_b64_tr_b16 a[60:61], v31 offset:61440
    ds_read_b64_tr_b16 a[62:63], v31 offset:63488
    s_waitcnt lgkmcnt(15)
    v_mfma_f32_32x32x16_bf16 v[160:175], a[0:3], v[48:51], v[160:175]
    v_exp_f32 v88, v88
    v_exp_f32 v89, v89
    s_waitcnt lgkmcnt(15)
    v_mfma_f32_32x32x16_bf16 v[176:191], a[4:7], v[48:51], v[176:191]
    v_exp_f32 v90, v90
    v_exp_f32 v91, v91
    v_cvt_pk_bf16_f32 v60, v88, v89
    s_add_u32 m0, s60, 17408
    s_add_u32 s66, s75, 16384
    buffer_load_dwordx4 v9, s[40:43], s66 offen lds
    s_waitcnt lgkmcnt(15)
    v_mfma_f32_32x32x16_bf16 v[192:207], a[8:11], v[48:51], v[192:207]
    v_exp_f32 v92, v92
    v_exp_f32 v93, v93
    v_cvt_pk_bf16_f32 v61, v90, v91
    s_waitcnt lgkmcnt(15)
    v_mfma_f32_32x32x16_bf16 v[208:223], a[12:15], v[48:51], v[208:223]
    v_exp_f32 v94, v94
    v_exp_f32 v95, v95
    v_cvt_pk_bf16_f32 v62, v92, v93
    s_add_u32 m0, s60, 24576
    s_nop 0
    buffer_load_dwordx4 v10, s[40:43], s75 offen lds
    s_waitcnt lgkmcnt(15)
    v_mfma_f32_32x32x16_bf16 v[160:175], a[16:19], v[52:55], v[160:175]
    v_cvt_pk_bf16_f32 v63, v94, v95
    v_max3_f32 v32, v96, v97, v98
    v_max3_f32 v33, v112, v113, v114
    s_waitcnt lgkmcnt(15)
    v_mfma_f32_32x32x16_bf16 v[176:191], a[20:23], v[52:55], v[176:191]
    v_max3_f32 v32, v32, v99, v100
    v_max3_f32 v33, v33, v115, v116
    v_max3_f32 v32, v32, v101, v102
    s_add_u32 m0, s60, 25600
    s_add_u32 s66, s75, 16384
    buffer_load_dwordx4 v10, s[40:43], s66 offen lds
    s_waitcnt lgkmcnt(15)
    v_mfma_f32_32x32x16_bf16 v[192:207], a[24:27], v[52:55], v[192:207]
    v_max3_f32 v33, v33, v117, v118
    v_max3_f32 v32, v32, v103, v104
    v_max3_f32 v33, v33, v119, v120
    s_waitcnt lgkmcnt(15)
    v_mfma_f32_32x32x16_bf16 v[208:223], a[28:31], v[52:55], v[208:223]
    v_max3_f32 v32, v32, v105, v106
    v_max3_f32 v33, v33, v121, v122
    v_max3_f32 v32, v32, v107, v108
    s_add_u32 m0, s60, 98304
    s_add_u32 s66, s75, 131072
    buffer_load_dwordx4 v9, s[40:43], s66 offen lds
    s_waitcnt lgkmcnt(14)
    v_mfma_f32_32x32x16_bf16 v[160:175], a[32:35], v[56:59], v[160:175]
    v_max3_f32 v33, v33, v123, v124
    v_max3_f32 v32, v32, v109, v110
    v_max3_f32 v33, v33, v125, v126
    s_waitcnt lgkmcnt(12)
    v_mfma_f32_32x32x16_bf16 v[176:191], a[36:39], v[56:59], v[176:191]
    v_max3_f32 v32, v32, v111, v127
    v_max_f32 v32, v32, v33
    v_pk_add_f32 v[224:225], v[224:225], v[64:65]
    s_add_u32 m0, s60, 99328
    s_add_u32 s66, s75, 147456
    buffer_load_dwordx4 v9, s[40:43], s66 offen lds
    s_waitcnt lgkmcnt(10)
    v_mfma_f32_32x32x16_bf16 v[192:207], a[40:43], v[56:59], v[192:207]
    v_pk_add_f32 v[224:225], v[224:225], v[66:67]
    v_pk_add_f32 v[224:225], v[224:225], v[68:69]
    v_pk_add_f32 v[224:225], v[224:225], v[70:71]
    s_add_u32 m0, s60, 106496
    s_add_u32 s66, s75, 131072
    buffer_load_dwordx4 v10, s[40:43], s66 offen lds
    s_waitcnt lgkmcnt(8)
    v_mfma_f32_32x32x16_bf16 v[208:223], a[44:47], v[56:59], v[208:223]
    v_pk_add_f32 v[224:225], v[224:225], v[72:73]
    v_pk_add_f32 v[224:225], v[224:225], v[74:75]
    v_pk_add_f32 v[224:225], v[224:225], v[76:77]
    s_waitcnt lgkmcnt(6)
    v_mfma_f32_32x32x16_bf16 v[160:175], a[48:51], v[60:63], v[160:175]
    v_pk_add_f32 v[224:225], v[224:225], v[78:79]
    v_pk_add_f32 v[224:225], v[224:225], v[80:81]
    v_pk_add_f32 v[224:225], v[224:225], v[82:83]
    s_add_u32 m0, s60, 107520
    s_add_u32 s66, s75, 147456
    buffer_load_dwordx4 v10, s[40:43], s66 offen lds
    s_waitcnt lgkmcnt(4)
    v_mfma_f32_32x32x16_bf16 v[176:191], a[52:55], v[60:63], v[176:191]
    v_pk_add_f32 v[224:225], v[224:225], v[84:85]
    v_pk_add_f32 v[224:225], v[224:225], v[86:87]
    v_pk_add_f32 v[224:225], v[224:225], v[88:89]
    s_waitcnt lgkmcnt(2)
    v_mfma_f32_32x32x16_bf16 v[192:207], a[56:59], v[60:63], v[192:207]
    v_pk_add_f32 v[224:225], v[224:225], v[90:91]
    v_pk_add_f32 v[224:225], v[224:225], v[92:93]
    v_pk_add_f32 v[224:225], v[224:225], v[94:95]
    s_waitcnt lgkmcnt(0)
    v_mfma_f32_32x32x16_bf16 v[208:223], a[60:63], v[60:63], v[208:223]
    v_cmp_lt_f32 vcc, 0x41000000, v32
    s_cbranch_vccz L_back7
    s_call_b64 s[72:73], L_rare1
L_back7:
    v_exp_f32 v96, v96
    v_exp_f32 v97, v97
    v_exp_f32 v98, v98
    v_exp_f32 v99, v99
    v_cvt_pk_bf16_f32 v48, v96, v97
    v_exp_f32 v100, v100
    v_exp_f32 v101, v101
    v_cvt_pk_bf16_f32 v49, v98, v99
    v_exp_f32 v102, v102
    v_exp_f32 v103, v103
    v_cvt_pk_bf16_f32 v50, v100, v101
    v_cvt_pk_bf16_f32 v51, v102, v103
    v_exp_f32 v104, v104
    v_exp_f32 v105, v105
    v_exp_f32 v106, v106
    v_exp_f32 v107, v107
    v_cvt_pk_bf16_f32 v52, v104, v105
    v_exp_f32 v108, v108
    v_exp_f32 v109, v109
    v_cvt_pk_bf16_f32 v53, v106, v107
    v_exp_f32 v110, v110
    v_exp_f32 v111, v111
    v_cvt_pk_bf16_f32 v54, v108, v109
    v_cvt_pk_bf16_f32 v55, v110, v111
    v_exp_f32 v112, v112
    v_exp_f32 v113, v113
    v_exp_f32 v114, v114
    v_exp_f32 v115, v115
    v_cvt_pk_bf16_f32 v56, v112, v113
    v_exp_f32 v116, v116
    v_exp_f32 v117, v117
    v_cvt_pk_bf16_f32 v57, v114, v115
    v_exp_f32 v118, v118
    v_exp_f32 v119, v119
    v_cvt_pk_bf16_f32 v58, v116, v117
    v_cvt_pk_bf16_f32 v59, v118, v119
    v_exp_f32 v120, v120
    v_exp_f32 v121, v121
    v_exp_f32 v122, v122
    v_exp_f32 v123, v123
    v_cvt_pk_bf16_f32 v60, v120, v121
    v_exp_f32 v124, v124
    v_exp_f32 v125, v125
    v_cvt_pk_bf16_f32 v61, v122, v123
    v_exp_f32 v126, v126
    v_exp_f32 v127, v127
    v_cvt_pk_bf16_f32 v62, v124, v125
    v_cvt_pk_bf16_f32 v63, v126, v127
    s_add_u32 m0, s60, 32768
    s_nop 0
    buffer_load_dwordx4 v9, s[40:43], s4 offen lds
    s_add_u32 m0, s60, 33792
    s_add_u32 s66, s4, 16384
    buffer_load_dwordx4 v9, s[40:43], s66 offen lds
    s_add_u32 m0, s60, 40960
    s_nop 0
    buffer_load_dwordx4 v10, s[40:43], s4 offen lds
    s_add_u32 m0, s60, 41984
    s_add_u32 s66, s4, 16384
    buffer_load_dwordx4 v10, s[40:43], s66 offen lds
    s_add_u32 m0, s60, 114688
    s_add_u32 s66, s4, 131072
    buffer_load_dwordx4 v9, s[40:43], s66 offen lds
    s_add_u32 m0, s60, 115712
    s_add_u32 s66, s4, 147456
    buffer_load_dwordx4 v9, s[40:43], s66 offen lds
    s_add_u32 m0, s60, 122880
    s_add_u32 s66, s4, 131072
    buffer_load_dwordx4 v10, s[40:43], s66 offen lds
    s_add_u32 m0, s60, 123904
    s_add_u32 s66, s4, 147456
    buffer_load_dwordx4 v10, s[40:43], s66 offen lds
    s_waitcnt vmcnt(16)
    s_barrier
    v_add_u32 v28, 0xffffc000, v28
    v_add_u32 v29, 0xffffc000, v29
    v_add_u32 v30, 0xffffc000, v30
    v_add_u32 v31, 0xffffc000, v31
    ds_read_b64_tr_b16 a[64:65], v28 offset:0
    ds_read_b64_tr_b16 a[66:67], v28 offset:2048
    ds_read_b64_tr_b16 a[80:81], v28 offset:4096
    ds_read_b64_tr_b16 a[82:83], v28 offset:6144
    ds_read_b64_tr_b16 a[96:97], v28 offset:8192
    ds_read_b64_tr_b16 a[98:99], v28 offset:10240
    ds_read_b64_tr_b16 a[112:113], v28 offset:12288
    ds_read_b64_tr_b16 a[114:115], v28 offset:14336
    ds_read_b64_tr_b16 a[68:69], v29 offset:0
    ds_read_b64_tr_b16 a[70:71], v29 offset:2048
    ds_read_b64_tr_b16 a[84:85], v29 offset:4096
    ds_read_b64_tr_b16 a[86:87], v29 offset:6144
    ds_read_b64_tr_b16 a[100:101], v29 offset:8192
    ds_read_b64_tr_b16 a[102:103], v29 offset:10240
    ds_read_b64_tr_b16 a[116:117], v29 offset:12288
    ds_read_b64_tr_b16 a[118:119], v29 offset:14336
    ds_read_b64_tr_b16 a[72:73], v30 offset:0
    ds_read_b64_tr_b16 a[74:75], v30 offset:2048
    ds_read_b64_tr_b16 a[88:89], v30 offset:4096
    ds_read_b64_tr_b16 a[90:91], v30 offset:6144
    ds_read_b64_tr_b16 a[104:105], v30 offset:8192
    ds_read_b64_tr_b16 a[106:107], v30 offset:10240
    ds_read_b64_tr_b16 a[120:121], v30 offset:12288
    ds_read_b64_tr_b16 a[122:123], v30 offset:14336
    ds_read_b64_tr_b16 a[76:77], v31 offset:0
    ds_read_b64_tr_b16 a[78:79], v31 offset:2048
    ds_read_b64_tr_b16 a[92:93], v31 offset:4096
    ds_read_b64_tr_b16 a[94:95], v31 offset:6144
    ds_read_b64_tr_b16 a[108:109], v31 offset:8192
    ds_read_b64_tr_b16 a[110:111], v31 offset:10240
    ds_read_b64_tr_b16 a[124:125], v31 offset:12288
    ds_read_b64_tr_b16 a[126:127], v31 offset:14336
    v_pk_add_f32 v[224:225], v[224:225], v[96:97]
    v_pk_add_f32 v[224:225], v[224:225], v[98:99]
    v_pk_add_f32 v[224:225], v[224:225], v[100:101]
    v_pk_add_f32 v[224:225], v[224:225], v[102:103]
    v_pk_add_f32 v[224:225], v[224:225], v[104:105]
    v_pk_add_f32 v[224:225], v[224:225], v[106:107]
    v_pk_add_f32 v[224:225], v[224:225], v[108:109]
    v_pk_add_f32 v[224:225], v[224:225], v[110:111]
    v_pk_add_f32 v[224:225], v[224:225], v[112:113]
    v_pk_add_f32 v[224:225], v[224:225], v[114:115]
    v_pk_add_f32 v[224:225], v[224:225], v[116:117]
    v_pk_add_f32 v[224:225], v[224:225], v[118:119]
    v_pk_add_f32 v[224:225], v[224:225], v[120:121]
    v_pk_add_f32 v[224:225], v[224:225], v[122:123]
    v_pk_add_f32 v[224:225], v[224:225], v[124:125]
    v_pk_add_f32 v[224:225], v[224:225], v[126:127]
    v_add_f32 v224, v224, v225
    v_mov_b32 v225, v224
    s_nop 1
    v_permlane32_swap_b32 v224, v225
    v_add_f32 v224, v224, v225
    v_rcp_f32 v224, v224
    s_nop 0
    v_mov_b32 v225, v224
    s_waitcnt lgkmcnt(15)
    v_mfma_f32_32x32x16_bf16 v[160:175], a[64:67], v[48:51], v[160:175]
    s_waitcnt lgkmcnt(15)
    v_mfma_f32_32x32x16_bf16 v[160:175], a[80:83], v[52:55], v[160:175]
    s_waitcnt lgkmcnt(15)
    v_mfma_f32_32x32x16_bf16 v[160:175], a[96:99], v[56:59], v[160:175]
    s_waitcnt lgkmcnt(15)
    v_mfma_f32_32x32x16_bf16 v[160:175], a[112:115], v[60:63], v[160:175]
    s_waitcnt lgkmcnt(15)
    v_mfma_f32_32x32x16_bf16 v[176:191], a[68:71], v[48:51], v[176:191]
    s_waitcnt lgkmcnt(15)
    v_mfma_f32_32x32x16_bf16 v[176:191], a[84:87], v[52:55], v[176:191]
    s_nop 7
    v_pk_mul_f32 v[160:161], v[160:161], v[224:225]
    v_pk_mul_f32 v[162:163], v[162:163], v[224:225]
    v_pk_mul_f32 v[164:165], v[164:165], v[224:225]
    v_pk_mul_f32 v[166:167], v[166:167], v[224:225]
    v_pk_mul_f32 v[168:169], v[168:169], v[224:225]
    v_pk_mul_f32 v[170:171], v[170:171], v[224:225]
    s_waitcnt lgkmcnt(15)
    v_mfma_f32_32x32x16_bf16 v[176:191], a[100:103], v[56:59], v[176:191]
    v_pk_mul_f32 v[172:173], v[172:173], v[224:225]
    v_pk_mul_f32 v[174:175], v[174:175], v[224:225]
    v_cvt_pk_bf16_f32 v128, v160, v161
    v_cvt_pk_bf16_f32 v129, v162, v163
    v_cvt_pk_bf16_f32 v130, v164, v165
    v_cvt_pk_bf16_f32 v131, v166, v167
    s_waitcnt lgkmcnt(15)
    v_mfma_f32_32x32x16_bf16 v[176:191], a[116:119], v[60:63], v[176:191]
    v_cvt_pk_bf16_f32 v132, v168, v169
    v_cvt_pk_bf16_f32 v133, v170, v171
    v_cvt_pk_bf16_f32 v134, v172, v173
    v_cvt_pk_bf16_f32 v135, v174, v175
    s_cmp_eq_u32 s68, 8
    s_cbranch_scc0 L_oslow0
    buffer_store_dwordx4 v[128:131], v11, s[36:39], s44 offen
    buffer_store_dwordx4 v[132:135], v11, s[36:39], s44 offen offset:1024
L_odone0:
    s_waitcnt lgkmcnt(14)
    v_mfma_f32_32x32x16_bf16 v[192:207], a[72:75], v[48:51], v[192:207]
    s_waitcnt lgkmcnt(12)
    v_mfma_f32_32x32x16_bf16 v[192:207], a[88:91], v[52:55], v[192:207]
    v_pk_mul_f32 v[176:177], v[176:177], v[224:225]
    v_pk_mul_f32 v[178:179], v[178:179], v[224:225]
    v_pk_mul_f32 v[180:181], v[180:181], v[224:225]
    v_pk_mul_f32 v[182:183], v[182:183], v[224:225]
    v_pk_mul_f32 v[184:185], v[184:185], v[224:225]
    v_pk_mul_f32 v[186:187], v[186:187], v[224:225]
    s_waitcnt lgkmcnt(10)
    v_mfma_f32_32x32x16_bf16 v[192:207], a[104:107], v[56:59], v[192:207]
    v_pk_mul_f32 v[188:189], v[188:189], v[224:225]
    v_pk_mul_f32 v[190:191], v[190:191], v[224:225]
    v_cvt_pk_bf16_f32 v136, v176, v177
    v_cvt_pk_bf16_f32 v137, v178, v179
    v_cvt_pk_bf16_f32 v138, v180, v181
    v_cvt_pk_bf16_f32 v139, v182, v183
    s_waitcnt lgkmcnt(8)
    v_mfma_f32_32x32x16_bf16 v[192:207], a[120:123], v[60:63], v[192:207]
    v_cvt_pk_bf16_f32 v140, v184, v185
    v_cvt_pk_bf16_f32 v141, v186, v187
    v_cvt_pk_bf16_f32 v142, v188, v189
    v_cvt_pk_bf16_f32 v143, v190, v191
    s_cmp_eq_u32 s68, 8
    s_cbranch_scc0 L_oslow1
    buffer_store_dwordx4 v[136:139], v11, s[36:39], s44 offen offset:2048
    buffer_store_dwordx4 v[140:143], v11, s[36:39], s44 offen offset:3072
L_odone1:
    s_waitcnt lgkmcnt(6)
    v_mfma_f32_32x32x16_bf16 v[208:223], a[76:79], v[48:51], v[208:223]
    s_waitcnt lgkmcnt(4)
    v_mfma_f32_32x32x16_bf16 v[208:223], a[92:95], v[52:55], v[208:223]
    v_pk_mul_f32 v[192:193], v[192:193], v[224:225]
    v_pk_mul_f32 v[194:195], v[194:195], v[224:225]
    v_pk_mul_f32 v[196:197], v[196:197], v[224:225]
    v_pk_mul_f32 v[198:199], v[198:199], v[224:225]
    v_pk_mul_f32 v[200:201], v[200:201], v[224:225]
    v_pk_mul_f32 v[202:203], v[202:203], v[224:225]
    s_waitcnt lgkmcnt(2)
    v_mfma_f32_32x32x16_bf16 v[208:223], a[108:111], v[56:59], v[208:223]
    v_pk_mul_f32 v[204:205], v[204:205], v[224:225]
    v_pk_mul_f32 v[206:207], v[206:207], v[224:225]
    v_cvt_pk_bf16_f32 v144, v192, v193
    v_cvt_pk_bf16_f32 v145, v194, v195
    v_cvt_pk_bf16_f32 v146, v196, v197
    v_cvt_pk_bf16_f32 v147, v198, v199
    s_waitcnt lgkmcnt(0)
    v_mfma_f32_32x32x16_bf16 v[208:223], a[124:127], v[60:63], v[208:223]
    v_cvt_pk_bf16_f32 v148, v200, v201
    v_cvt_pk_bf16_f32 v149, v202, v203
    v_cvt_pk_bf16_f32 v150, v204, v205
    v_cvt_pk_bf16_f32 v151, v206, v207
    s_cmp_eq_u32 s68, 8
    s_cbranch_scc0 L_oslow2
    buffer_store_dwordx4 v[144:147], v11, s[36:39], s46 offen
    buffer_store_dwordx4 v[148:151], v11, s[36:39], s46 offen offset:1024
L_odone2:
    s_nop 3
    v_pk_mul_f32 v[208:209], v[208:209], v[224:225]
    v_pk_mul_f32 v[210:211], v[210:211], v[224:225]
    v_pk_mul_f32 v[212:213], v[212:213], v[224:225]
    v_pk_mul_f32 v[214:215], v[214:215], v[224:225]
    v_pk_mul_f32 v[216:217], v[216:217], v[224:225]
    v_pk_mul_f32 v[218:219], v[218:219], v[224:225]
    v_pk_mul_f32 v[220:221], v[220:221], v[224:225]
    v_pk_mul_f32 v[222:223], v[222:223], v[224:225]
    v_cvt_pk_bf16_f32 v152, v208, v209
    v_cvt_pk_bf16_f32 v153, v210, v211
    v_cvt_pk_bf16_f32 v154, v212, v213
    v_cvt_pk_bf16_f32 v155, v214, v215
    v_cvt_pk_bf16_f32 v156, v216, v217
    v_cvt_pk_bf16_f32 v157, v218, v219
    v_cvt_pk_bf16_f32 v158, v220, v221
    v_cvt_pk_bf16_f32 v159, v222, v223
    s_cmp_eq_u32 s68, 8
    s_cbranch_scc0 L_oslow3
    buffer_store_dwordx4 v[152:155], v11, s[36:39], s46 offen offset:2048
    buffer_store_dwordx4 v[156:159], v11, s[36:39], s46 offen offset:3072
L_odone3:
    s_waitcnt vmcnt(16)
    s_barrier
    v_mov_b32 v163, s70
    v_mov_b32 v167, s70
    v_mov_b32 v171, s70
    v_mov_b32 v175, s70
    v_mov_b32 v179, s70
    v_mov_b32 v183, s70
    v_mov_b32 v187, s70
    v_mov_b32 v191, s70
    v_mov_b32 v195, s70
    v_mov_b32 v170, 0
    v_mov_b32 v182, 0
    v_mov_b32 v194, 0
    ds_read_b64_tr_b16 a[224:225], v12 offset:16384
    ds_read_b64_tr_b16 a[226:227], v12 offset:17408
    ds_read_b64_tr_b16 a[228:229], v13 offset:16384
    ds_read_b64_tr_b16 a[230:231], v13 offset:17408
    ds_read_b64_tr_b16 a[232:233], v13 offset:24576
    ds_read_b64_tr_b16 a[234:235], v13 offset:25600
    ds_read_b64_tr_b16 a[236:237], v12 offset:24576
    ds_read_b64_tr_b16 a[238:239], v12 offset:25600
    ds_read_b64_tr_b16 a[240:241], v12 offset:18432
    ds_read_b64_tr_b16 a[242:243], v12 offset:19456
    ds_read_b64_tr_b16 a[244:245], v13 offset:18432
    ds_read_b64_tr_b16 a[246:247], v13 offset:19456
    s_waitcnt lgkmcnt(10)
    v_mfma_f32_32x32x16_bf16 v[96:111], a[224:227], v[128:131], 0
    ds_read_b64_tr_b16 a[248:249], v13 offset:26624
    ds_read_b64_tr_b16 a[250:251], v13 offset:27648
    s_waitcnt lgkmcnt(10)
    v_mfma_f32_32x32x16_bf16 v[112:127], a[228:231], v[128:131], 0
    ds_read_b64_tr_b16 a[252:253], v12 offset:26624
    ds_read_b64_tr_b16 a[254:255], v12 offset:27648
    s_waitcnt lgkmcnt(10)
    v_mfma_f32_32x32x16_bf16 v[80:95], a[232:235], v[128:131], 0
    ds_read_b64_tr_b16 a[224:225], v12 offset:20480
    ds_read_b64_tr_b16 a[226:227], v12 offset:21504
    s_waitcnt lgkmcnt(10)
    v_mfma_f32_32x32x16_bf16 v[64:79], a[236:239], v[128:131], 0
    ds_read_b64_tr_b16 a[228:229], v13 offset:20480
    ds_read_b64_tr_b16 a[230:231], v13 offset:21504
    s_waitcnt lgkmcnt(10)
    v_mfma_f32_32x32x16_bf16 v[96:111], a[240:243], v[132:135], v[96:111]
    ds_read_b64_tr_b16 a[232:233], v13 offset:28672
    ds_read_b64_tr_b16 a[234:235], v13 offset:29696
    s_waitcnt lgkmcnt(10)
    v_mfma_f32_32x32x16_bf16 v[112:127], a[244:247], v[132:135], v[112:127]
    ds_read_b64_tr_b16 a[236:237], v12 offset:28672
    ds_read_b64_tr_b16 a[238:239], v12 offset:29696
    s_waitcnt lgkmcnt(10)
    v_mfma_f32_32x32x16_bf16 v[80:95], a[248:251], v[132:135], v[80:95]
    ds_read_b64_tr_b16 a[240:241], v12 offset:22528
    ds_read_b64_tr_b16 a[242:243], v12 offset:23552
    s_waitcnt lgkmcnt(10)
    v_mfma_f32_32x32x16_bf16 v[64:79], a[252:255], v[132:135], v[64:79]
    ds_read_b64_tr_b16 a[244:245], v13 offset:22528
    ds_read_b64_tr_b16 a[246:247], v13 offset:23552
    s_add_u32 m0, s60, 49152
    s_waitcnt vmcnt(0)
    s_mov_b64 exec, 1
    s_cmp_eq_u32 s68, 8
    s_cbranch_scc0 L_fslow
    buffer_store_dword v35, v34, s[36:39], s48 offen
L_fdone:
    s_mov_b64 exec, -1
    s_waitcnt lgkmcnt(10)
    v_mfma_f32_32x32x16_bf16 v[96:111], a[224:227], v[136:139], v[96:111]
    buffer_load_dwordx4 v9, s[40:43], s5 offen lds
    ds_read_b64_tr_b16 a[248:249], v13 offset:30720
    ds_read_b64_tr_b16 a[250:251], v13 offset:31744
    s_add_u32 m0, s60, 50176
    s_add_u32 s66, s5, 16384
    s_waitcnt lgkmcnt(10)
    v_mfma_f32_32x32x16_bf16 v[112:127], a[228:231], v[136:139], v[112:127]
    buffer_load_dwordx4 v9, s[40:43], s66 offen lds
    ds_read_b64_tr_b16 a[252:253], v12 offset:30720
    ds_read_b64_tr_b16 a[254:255], v12 offset:31744
    s_add_u32 m0, s60, 57344
    s_waitcnt lgkmcnt(10)
    v_mfma_f32_32x32x16_bf16 v[80:95], a[232:235], v[136:139], v[80:95]
    buffer_load_dwordx4 v10, s[40:43], s5 offen lds
    ds_read_b64_tr_b16 a[224:225], v14 offset:32768
    ds_read_b64_tr_b16 a[226:227], v14 offset:33792
    s_add_u32 m0, s60, 58368
    s_add_u32 s66, s5, 16384
    s_waitcnt lgkmcnt(10)
    v_mfma_f32_32x32x16_bf16 v[64:79], a[236:239], v[136:139], v[64:79]
    buffer_load_dwordx4 v10, s[40:43], s66 offen lds
    ds_read_b64_tr_b16 a[228:229], v15 offset:32768
    ds_read_b64_tr_b16 a[230:231], v15 offset:33792
    s_add_u32 m0, s60, 131072
    s_add_u32 s66, s5, 131072
    s_waitcnt lgkmcnt(10)
    v_mfma_f32_32x32x16_bf16 v[96:111], a[240:243], v[140:143], v[96:111]
    buffer_load_dwordx4 v9, s[40:43], s66 offen lds
    ds_read_b64_tr_b16 a[232:233], v15 offset:40960
    ds_read_b64_tr_b16 a[234:235], v15 offset:41984
    s_add_u32 m0, s60, 132096
    s_add_u32 s66, s5, 147456
    s_waitcnt lgkmcnt(10)
    v_mfma_f32_32x32x16_bf16 v[112:127], a[244:247], v[140:143], v[112:127]
    buffer_load_dwordx4 v9, s[40:43], s66 offen lds
    ds_read_b64_tr_b16 a[236:237], v14 offset:40960
    ds_read_b64_tr_b16 a[238:239], v14 offset:41984
    s_add_u32 m0, s60, 139264
    s_add_u32 s66, s5, 131072
    s_waitcnt lgkmcnt(10)
    v_mfma_f32_32x32x16_bf16 v[80:95], a[248:251], v[140:143], v[80:95]
    buffer_load_dwordx4 v10, s[40:43], s66 offen lds
    ds_read_b64_tr_b16 a[240:241], v14 offset:34816
    ds_read_b64_tr_b16 a[242:243], v14 offset:35840
    s_add_u32 m0, s60, 140288
    s_add_u32 s66, s5, 147456
    s_waitcnt lgkmcnt(10)
    v_mfma_f32_32x32x16_bf16 v[64:79], a[252:255], v[140:143], v[64:79]
    buffer_load_dwordx4 v10, s[40:43], s66 offen lds
    ds_read_b64_tr_b16 a[244:245], v15 offset:34816
    ds_read_b64_tr_b16 a[246:247], v15 offset:35840
    s_add_u32 m0, s60, 65536
    s_waitcnt lgkmcnt(10)
    v_mfma_f32_32x32x16_bf16 v[96:111], a[224:227], v[144:147], v[96:111]
    buffer_load_dwordx4 v9, s[40:43], s6 offen lds
    ds_read_b64_tr_b16 a[248:249], v15 offset:43008
    ds_read_b64_tr_b16 a[250:251], v15 offset:44032
    s_add_u32 m0, s60, 66560
    s_add_u32 s66, s6, 16384
    s_waitcnt lgkmcnt(10)
    v_mfma_f32_32x32x16_bf16 v[112:127], a[228:231], v[144:147], v[112:127]
    buffer_load_dwordx4 v9, s[40:43], s66 offen lds
    ds_read_b64_tr_b16 a[252:253], v14 offset:43008
    ds_read_b64_tr_b16 a[254:255], v14 offset:44032
    s_add_u32 m0, s60, 73728
    s_add_u32 s66, s6, 131072
    s_waitcnt lgkmcnt(10)
    v_mfma_f32_32x32x16_bf16 v[80:95], a[232:235], v[144:147], v[80:95]
    buffer_load_dwordx4 v9, s[40:43], s66 offen lds
    ds_read_b64_tr_b16 a[224:225], v14 offset:36864
    ds_read_b64_tr_b16 a[226:227], v14 offset:37888
    s_add_u32 m0, s60, 74752
    s_add_u32 s66, s6, 147456
    s_waitcnt lgkmcnt(10)
    v_mfma_f32_32x32x16_bf16 v[64:79], a[236:239], v[144:147], v[64:79]
    buffer_load_dwordx4 v9, s[40:43], s66 offen lds
    ds_read_b64_tr_b16 a[228:229], v15 offset:36864
    ds_read_b64_tr_b16 a[230:231], v15 offset:37888
    s_add_u32 m0, s60, 147456
    s_waitcnt lgkmcnt(10)
    v_mfma_f32_32x32x16_bf16 v[96:111], a[240:243], v[148:151], v[96:111]
    buffer_load_dwordx4 v9, s[40:43], s7 offen lds
    ds_read_b64_tr_b16 a[232:233], v15 offset:45056
    ds_read_b64_tr_b16 a[234:235], v15 offset:46080
    s_add_u32 m0, s60, 148480
    s_add_u32 s66, s7, 16384
    s_waitcnt lgkmcnt(10)
    v_mfma_f32_32x32x16_bf16 v[112:127], a[244:247], v[148:151], v[112:127]
    buffer_load_dwordx4 v9, s[40:43], s66 offen lds
    ds_read_b64_tr_b16 a[236:237], v14 offset:45056
    ds_read_b64_tr_b16 a[238:239], v14 offset:46080
    s_add_u32 m0, s60, 155648
    s_add_u32 s66, s7, 131072
    s_waitcnt lgkmcnt(10)
    v_mfma_f32_32x32x16_bf16 v[80:95], a[248:251], v[148:151], v[80:95]
    buffer_load_dwordx4 v9, s[40:43], s66 offen lds
    ds_read_b64_tr_b16 a[240:241], v14 offset:38912
    ds_read_b64_tr_b16 a[242:243], v14 offset:39936
    s_add_u32 m0, s60, 156672
    s_add_u32 s66, s7, 147456
    s_waitcnt lgkmcnt(10)
    v_mfma_f32_32x32x16_bf16 v[64:79], a[252:255], v[148:151], v[64:79]
    buffer_load_dwordx4 v9, s[40:43], s66 offen lds
    ds_read_b64_tr_b16 a[244:245], v15 offset:38912
    ds_read_b64_tr_b16 a[246:247], v15 offset:39936
    s_add_u32 m0, s60, 0
    s_waitcnt lgkmcnt(10)
    v_mfma_f32_32x32x16_bf16 v[96:111], a[224:227], v[152:155], v[96:111]
    buffer_load_dwordx4 v9, s[40:43], s8 offen lds
    ds_read_b64_tr_b16 a[248:249], v15 offset:47104
    ds_read_b64_tr_b16 a[250:251], v15 offset:48128
    s_add_u32 m0, s60, 1024
    s_add_u32 s66, s8, 16384
    s_waitcnt lgkmcnt(10)
    v_mfma_f32_32x32x16_bf16 v[112:127], a[228:231], v[152:155], v[112:127]
    buffer_load_dwordx4 v9, s[40:43], s66 offen lds
    ds_read_b64_tr_b16 a[252:253], v14 offset:47104
    ds_read_b64_tr_b16 a[254:255], v14 offset:48128
    s_add_u32 m0, s60, 8192
    s_add_u32 s66, s8, 131072
    s_waitcnt lgkmcnt(10)
    v_mfma_f32_32x32x16_bf16 v[80:95], a[232:235], v[152:155], v[80:95]
    buffer_load_dwordx4 v9, s[40:43], s66 offen lds
    s_waitcnt vmcnt(17)
    s_waitcnt vmcnt(15)
    s_barrier
    ds_read_b64_tr_b16 a[224:225], v12 offset:32768
    ds_read_b64_tr_b16 a[226:227], v12 offset:33792
    s_add_u32 m0, s60, 9216
    s_add_u32 s66, s8, 147456
    s_waitcnt lgkmcnt(10)
    v_mfma_f32_32x32x16_bf16 v[64:79], a[236:239], v[152:155], v[64:79]
    buffer_load_dwordx4 v9, s[40:43], s66 offen lds
    ds_read_b64_tr_b16 a[228:229], v13 offset:32768
    ds_read_b64_tr_b16 a[230:231], v13 offset:33792
    s_add_u32 m0, s60, 81920
    s_waitcnt lgkmcnt(10)
    v_mfma_f32_32x32x16_bf16 v[96:111], a[240:243], v[156:159], v[96:111]
    buffer_load_dwordx4 v9, s[40:43], s9 offen lds
    ds_read_b64_tr_b16 a[232:233], v13 offset:40960
    ds_read_b64_tr_b16 a[234:235], v13 offset:41984
    s_add_u32 m0, s60, 82944
    s_add_u32 s66, s9, 16384
    s_waitcnt lgkmcnt(10)
    v_mfma_f32_32x32x16_bf16 v[112:127], a[244:247], v[156:159], v[112:127]
    buffer_load_dwordx4 v9, s[40:43], s66 offen lds
    ds_read_b64_tr_b16 a[236:237], v12 offset:40960
    ds_read_b64_tr_b16 a[238:239], v12 offset:41984
    s_add_u32 m0, s60, 90112
    s_add_u32 s66, s9, 131072
    s_waitcnt lgkmcnt(10)
    v_mfma_f32_32x32x16_bf16 v[80:95], a[248:251], v[156:159], v[80:95]
    buffer_load_dwordx4 v9, s[40:43], s66 offen lds
    ds_read_b64_tr_b16 a[240:241], v12 offset:34816
    ds_read_b64_tr_b16 a[242:243], v12 offset:35840
    s_add_u32 m0, s60, 91136
    s_add_u32 s66, s9, 147456
    s_waitcnt lgkmcnt(10)
    v_mfma_f32_32x32x16_bf16 v[64:79], a[252:255], v[156:159], v[64:79]
    buffer_load_dwordx4 v9, s[40:43], s66 offen lds
    ds_read_b64_tr_b16 a[244:245], v13 offset:34816
    ds_read_b64_tr_b16 a[246:247], v13 offset:35840
    s_add_u32 m0, s60, 16384
    s_barrier
    buffer_load_dwordx4 v10, s[40:43], s6 offen lds
    s_add_u32 m0, s60, 17408
    s_add_u32 s66, s6, 16384
    buffer_load_dwordx4 v10, s[40:43], s66 offen lds
    s_add_u32 m0, s60, 24576
    s_add_u32 s66, s6, 131072
    buffer_load_dwordx4 v10, s[40:43], s66 offen lds
    s_add_u32 m0, s60, 25600
    s_add_u32 s66, s6, 147456
    buffer_load_dwordx4 v10, s[40:43], s66 offen lds
    s_add_u32 m0, s60, 98304
    s_nop 0
    buffer_load_dwordx4 v9, s[40:43], s10 offen lds
    s_add_u32 m0, s60, 99328
    s_add_u32 s66, s10, 16384
    buffer_load_dwordx4 v9, s[40:43], s66 offen lds
    s_add_u32 m0, s60, 106496
    s_add_u32 s66, s10, 131072
    buffer_load_dwordx4 v9, s[40:43], s66 offen lds
    s_add_u32 m0, s60, 107520
    s_add_u32 s66, s10, 147456
    buffer_load_dwordx4 v9, s[40:43], s66 offen lds
    s_mov_b32 s71, 0
L_pollo:
    buffer_load_dword v37, v36, s[36:39], s48 offen sc1
    s_waitcnt vmcnt(0)
    v_cmp_ne_u32 vcc, s70, v37
    s_add_u32 s71, s71, 1
    s_cbranch_vccz L_pollo_ok
    s_cmp_lt_u32 s71, 65536
    s_cbranch_scc1 L_pollo
L_pollo_ok:
    buffer_load_dwordx4 a[0:3], v11, s[36:39], s11 offen sc1
    buffer_load_dwordx4 a[4:7], v11, s[36:39], s11 offen offset:1024 sc1
    buffer_load_dwordx4 a[8:11], v11, s[36:39], s11 offen offset:2048 sc1
    buffer_load_dwordx4 a[12:15], v11, s[36:39], s11 offen offset:3072 sc1
    s_add_u32 s63, s11, 4096
    buffer_load_dwordx4 a[16:19], v11, s[36:39], s63 offen sc1
    buffer_load_dwordx4 a[20:23], v11, s[36:39], s63 offen offset:1024 sc1
    buffer_load_dwordx4 a[24:27], v11, s[36:39], s63 offen offset:2048 sc1
    buffer_load_dwordx4 a[28:31], v11, s[36:39], s63 offen offset:3072 sc1
    buffer_load_dwordx4 a[32:35], v11, s[36:39], s12 offen sc1
    buffer_load_dwordx4 a[36:39], v11, s[36:39], s12 offen offset:1024 sc1
    s_waitcnt vmcnt(9) lgkmcnt(10)
    v_mfma_f32_32x32x16_bf16 v[96:111], a[224:227], a[0:3], v[96:111]
    ds_read_b64_tr_b16 a[248:249], v13 offset:43008
    ds_read_b64_tr_b16 a[250:251], v13 offset:44032
    s_waitcnt lgkmcnt(10)
    v_mfma_f32_32x32x16_bf16 v[112:127], a[228:231], a[0:3], v[112:127]
    buffer_load_dwordx4 a[40:43], v11, s[36:39], s12 offen offset:2048 sc1
    ds_read_b64_tr_b16 a[252:253], v12 offset:43008
    ds_read_b64_tr_b16 a[254:255], v12 offset:44032
    s_waitcnt lgkmcnt(10)
    v_mfma_f32_32x32x16_bf16 v[80:95], a[232:235], a[0:3], v[80:95]
    ds_read_b64_tr_b16 a[224:225], v12 offset:36864
    ds_read_b64_tr_b16 a[226:227], v12 offset:37888
    s_waitcnt lgkmcnt(10)
    v_mfma_f32_32x32x16_bf16 v[64:79], a[236:239], a[0:3], v[64:79]
    buffer_load_dwordx4 a[44:47], v11, s[36:39], s12 offen offset:3072 sc1
    ds_read_b64_tr_b16 a[228:229], v13 offset:36864
    ds_read_b64_tr_b16 a[230:231], v13 offset:37888
    s_add_u32 s63, s12, 4096
    s_waitcnt vmcnt(10) lgkmcnt(10)
    v_mfma_f32_32x32x16_bf16 v[96:111], a[240:243], a[4:7], v[96:111]
    ds_read_b64_tr_b16 a[232:233], v13 offset:45056
    ds_read_b64_tr_b16 a[234:235], v13 offset:46080
    s_waitcnt lgkmcnt(10)
    v_mfma_f32_32x32x16_bf16 v[112:127], a[244:247], a[4:7], v[112:127]
    buffer_load_dwordx4 a[48:51], v11, s[36:39], s63 offen sc1
    ds_read_b64_tr_b16 a[236:237], v12 offset:45056
    ds_read_b64_tr_b16 a[238:239], v12 offset:46080
    s_waitcnt lgkmcnt(10)
    v_mfma_f32_32x32x16_bf16 v[80:95], a[248:251], a[4:7], v[80:95]
    ds_read_b64_tr_b16 a[240:241], v12 offset:38912
    ds_read_b64_tr_b16 a[242:243], v12 offset:39936
    s_waitcnt lgkmcnt(10)
    v_mfma_f32_32x32x16_bf16 v[64:79], a[252:255], a[4:7], v[64:79]
    buffer_load_dwordx4 a[52:55], v11, s[36:39], s63 offen offset:1024 sc1
    ds_read_b64_tr_b16 a[244:245], v13 offset:38912
    ds_read_b64_tr_b16 a[246:247], v13 offset:39936
    s_waitcnt vmcnt(11) lgkmcnt(10)
    v_mfma_f32_32x32x16_bf16 v[96:111], a[224:227], a[8:11], v[96:111]
    ds_read_b64_tr_b16 a[248:249], v13 offset:47104
    ds_read_b64_tr_b16 a[250:251], v13 offset:48128
    s_waitcnt lgkmcnt(10)
    v_mfma_f32_32x32x16_bf16 v[112:127], a[228:231], a[8:11], v[112:127]
    buffer_load_dwordx4 a[56:59], v11, s[36:39], s63 offen offset:2048 sc1
    ds_read_b64_tr_b16 a[252:253], v12 offset:47104
    ds_read_b64_tr_b16 a[254:255], v12 offset:48128
    s_waitcnt lgkmcnt(10)
    v_mfma_f32_32x32x16_bf16 v[80:95], a[232:235], a[8:11], v[80:95]
    ds_read_b64_tr_b16 a[224:225], v14 offset:49152
    ds_read_b64_tr_b16 a[226:227], v14 offset:50176
    s_waitcnt lgkmcnt(10)
    v_mfma_f32_32x32x16_bf16 v[64:79], a[236:239], a[8:11], v[64:79]
    buffer_load_dwordx4 a[60:63], v11, s[36:39], s63 offen offset:3072 sc1
    ds_read_b64_tr_b16 a[228:229], v15 offset:49152
    ds_read_b64_tr_b16 a[230:231], v15 offset:50176
    s_waitcnt vmcnt(12) lgkmcnt(10)
    v_mfma_f32_32x32x16_bf16 v[96:111], a[240:243], a[12:15], v[96:111]
    ds_read_b64_tr_b16 a[232:233], v15 offset:57344
    ds_read_b64_tr_b16 a[234:235], v15 offset:58368
    s_waitcnt lgkmcnt(10)
    v_mfma_f32_32x32x16_bf16 v[112:127], a[244:247], a[12:15], v[112:127]
    buffer_load_dwordx4 a[64:67], v11, s[36:39], s13 offen sc1
    ds_read_b64_tr_b16 a[236:237], v14 offset:57344
    ds_read_b64_tr_b16 a[238:239], v14 offset:58368
    s_waitcnt lgkmcnt(10)
    v_mfma_f32_32x32x16_bf16 v[80:95], a[248:251], a[12:15], v[80:95]
    ds_read_b64_tr_b16 a[240:241], v14 offset:51200
    ds_read_b64_tr_b16 a[242:243], v14 offset:52224
    s_waitcnt lgkmcnt(10)
    v_mfma_f32_32x32x16_bf16 v[64:79], a[252:255], a[12:15], v[64:79]
    buffer_load_dwordx4 a[68:71], v11, s[36:39], s13 offen offset:1024 sc1
    ds_read_b64_tr_b16 a[244:245], v15 offset:51200
    ds_read_b64_tr_b16 a[246:247], v15 offset:52224
    s_waitcnt vmcnt(13) lgkmcnt(10)
    v_mfma_f32_32x32x16_bf16 v[96:111], a[224:227], a[16:19], v[96:111]
    ds_read_b64_tr_b16 a[248:249], v15 offset:59392
    ds_read_b64_tr_b16 a[250:251], v15 offset:60416
    s_waitcnt lgkmcnt(10)
    v_mfma_f32_32x32x16_bf16 v[112:127], a[228:231], a[16:19], v[112:127]
    buffer_load_dwordx4 a[72:75], v11, s[36:39], s13 offen offset:2048 sc1
    ds_read_b64_tr_b16 a[252:253], v14 offset:59392
    ds_read_b64_tr_b16 a[254:255], v14 offset:60416
    s_waitcnt lgkmcnt(10)
    v_mfma_f32_32x32x16_bf16 v[80:95], a[232:235], a[16:19], v[80:95]
    ds_read_b64_tr_b16 a[224:225], v14 offset:53248
    ds_read_b64_tr_b16 a[226:227], v14 offset:54272
    s_waitcnt lgkmcnt(10)
    v_mfma_f32_32x32x16_bf16 v[64:79], a[236:239], a[16:19], v[64:79]
    buffer_load_dwordx4 a[76:79], v11, s[36:39], s13 offen offset:3072 sc1
    ds_read_b64_tr_b16 a[228:229], v15 offset:53248
    ds_read_b64_tr_b16 a[230:231], v15 offset:54272
    s_add_u32 s63, s13, 4096
    s_waitcnt vmcnt(14) lgkmcnt(10)
    v_mfma_f32_32x32x16_bf16 v[96:111], a[240:243], a[20:23], v[96:111]
    ds_read_b64_tr_b16 a[232:233], v15 offset:61440
    ds_read_b64_tr_b16 a[234:235], v15 offset:62464
    s_waitcnt lgkmcnt(10)
    v_mfma_f32_32x32x16_bf16 v[112:127], a[244:247], a[20:23], v[112:127]
    buffer_load_dwordx4 a[80:83], v11, s[36:39], s63 offen sc1
    ds_read_b64_tr_b16 a[236:237], v14 offset:61440
    ds_read_b64_tr_b16 a[238:239], v14 offset:62464
    s_waitcnt lgkmcnt(10)
    v_mfma_f32_32x32x16_bf16 v[80:95], a[248:251], a[20:23], v[80:95]
    ds_read_b64_tr_b16 a[240:241], v14 offset:55296
    ds_read_b64_tr_b16 a[242:243], v14 offset:56320
    s_waitcnt lgkmcnt(10)
    v_mfma_f32_32x32x16_bf16 v[64:79], a[252:255], a[20:23], v[64:79]
    buffer_load_dwordx4 a[84:87], v11, s[36:39], s63 offen offset:1024 sc1
    ds_read_b64_tr_b16 a[244:245], v15 offset:55296
    ds_read_b64_tr_b16 a[246:247], v15 offset:56320
    s_waitcnt vmcnt(15) lgkmcnt(10)
    v_mfma_f32_32x32x16_bf16 v[96:111], a[224:227], a[24:27], v[96:111]
    ds_read_b64_tr_b16 a[248:249], v15 offset:63488
    ds_read_b64_tr_b16 a[250:251], v15 offset:64512
    s_waitcnt lgkmcnt(10)
    v_mfma_f32_32x32x16_bf16 v[112:127], a[228:231], a[24:27], v[112:127]
    buffer_load_dwordx4 a[88:91], v11, s[36:39], s63 offen offset:2048 sc1
    ds_read_b64_tr_b16 a[252:253], v14 offset:63488
    ds_read_b64_tr_b16 a[254:255], v14 offset:64512
    s_waitcnt lgkmcnt(10)
    v_mfma_f32_32x32x16_bf16 v[80:95], a[232:235], a[24:27], v[80:95]
    ds_read_b64_tr_b16 a[224:225], v12 offset:49152
    ds_read_b64_tr_b16 a[226:227], v12 offset:50176
    s_waitcnt lgkmcnt(10)
    v_mfma_f32_32x32x16_bf16 v[64:79], a[236:239], a[24:27], v[64:79]
    buffer_load_dwordx4 a[92:95], v11, s[36:39], s63 offen offset:3072 sc1
    ds_read_b64_tr_b16 a[228:229], v13 offset:49152
    ds_read_b64_tr_b16 a[230:231], v13 offset:50176
    s_waitcnt vmcnt(16) lgkmcnt(10)
    v_mfma_f32_32x32x16_bf16 v[96:111], a[240:243], a[28:31], v[96:111]
    ds_read_b64_tr_b16 a[232:233], v13 offset:57344
    ds_read_b64_tr_b16 a[234:235], v13 offset:58368
    s_waitcnt lgkmcnt(10)
    v_mfma_f32_32x32x16_bf16 v[112:127], a[244:247], a[28:31], v[112:127]
    buffer_load_dwordx4 a[96:99], v11, s[36:39], s32 offen sc1
    ds_read_b64_tr_b16 a[236:237], v12 offset:57344
    ds_read_b64_tr_b16 a[238:239], v12 offset:58368
    s_waitcnt lgkmcnt(10)
    v_mfma_f32_32x32x16_bf16 v[80:95], a[248:251], a[28:31], v[80:95]
    ds_read_b64_tr_b16 a[240:241], v12 offset:51200
    ds_read_b64_tr_b16 a[242:243], v12 offset:52224
    s_waitcnt lgkmcnt(10)
    v_mfma_f32_32x32x16_bf16 v[64:79], a[252:255], a[28:31], v[64:79]
    buffer_load_dwordx4 a[100:103], v11, s[36:39], s32 offen offset:1024 sc1
    ds_read_b64_tr_b16 a[244:245], v13 offset:51200
    ds_read_b64_tr_b16 a[246:247], v13 offset:52224
    s_waitcnt vmcnt(17) lgkmcnt(10)
    v_mfma_f32_32x32x16_bf16 v[96:111], a[224:227], a[32:35], v[96:111]
    ds_read_b64_tr_b16 a[248:249], v13 offset:59392
    ds_read_b64_tr_b16 a[250:251], v13 offset:60416
    s_waitcnt lgkmcnt(10)
    v_mfma_f32_32x32x16_bf16 v[112:127], a[228:231], a[32:35], v[112:127]
    buffer_load_dwordx4 a[104:107], v11, s[36:39], s32 offen offset:2048 sc1
    ds_read_b64_tr_b16 a[252:253], v12 offset:59392
    ds_read_b64_tr_b16 a[254:255], v12 offset:60416
    s_barrier
    s_waitcnt lgkmcnt(10)
    v_mfma_f32_32x32x16_bf16 v[80:95], a[232:235], a[32:35], v[80:95]
    ds_read_b64_tr_b16 a[224:225], v12 offset:53248
    ds_read_b64_tr_b16 a[226:227], v12 offset:54272
    s_waitcnt lgkmcnt(10)
    v_mfma_f32_32x32x16_bf16 v[64:79], a[236:239], a[32:35], v[64:79]
    buffer_load_dwordx4 a[108:111], v11, s[36:39], s32 offen offset:3072 sc1
    ds_read_b64_tr_b16 a[228:229], v13 offset:53248
    ds_read_b64_tr_b16 a[230:231], v13 offset:54272
    s_add_u32 s63, s32, 4096
    s_waitcnt vmcnt(18) lgkmcnt(10)
    v_mfma_f32_32x32x16_bf16 v[96:111], a[240:243], a[36:39], v[96:111]
    ds_read_b64_tr_b16 a[232:233], v13 offset:61440
    ds_read_b64_tr_b16 a[234:235], v13 offset:62464
    s_waitcnt lgkmcnt(10)
    v_mfma_f32_32x32x16_bf16 v[112:127], a[244:247], a[36:39], v[112:127]
    buffer_load_dwordx4 a[112:115], v11, s[36:39], s63 offen sc1
    ds_read_b64_tr_b16 a[236:237], v12 offset:61440
    ds_read_b64_tr_b16 a[238:239], v12 offset:62464
    s_waitcnt lgkmcnt(10)
    v_mfma_f32_32x32x16_bf16 v[80:95], a[248:251], a[36:39], v[80:95]
    ds_read_b64_tr_b16 a[240:241], v12 offset:55296
    ds_read_b64_tr_b16 a[242:243], v12 offset:56320
    s_waitcnt lgkmcnt(10)
    v_mfma_f32_32x32x16_bf16 v[64:79], a[252:255], a[36:39], v[64:79]
    buffer_load_dwordx4 a[116:119], v11, s[36:39], s63 offen offset:1024 sc1
    ds_read_b64_tr_b16 a[244:245], v13 offset:55296
    ds_read_b64_tr_b16 a[246:247], v13 offset:56320
    s_waitcnt vmcnt(19) lgkmcnt(10)
    v_mfma_f32_32x32x16_bf16 v[96:111], a[224:227], a[40:43], v[96:111]
    ds_read_b64_tr_b16 a[248:249], v13 offset:63488
    ds_read_b64_tr_b16 a[250:251], v13 offset:64512
    s_waitcnt lgkmcnt(10)
    v_mfma_f32_32x32x16_bf16 v[112:127], a[228:231], a[40:43], v[112:127]
    buffer_load_dwordx4 a[120:123], v11, s[36:39], s63 offen offset:2048 sc1
    ds_read_b64_tr_b16 a[252:253], v12 offset:63488
    ds_read_b64_tr_b16 a[254:255], v12 offset:64512
    s_waitcnt lgkmcnt(10)
    v_mfma_f32_32x32x16_bf16 v[80:95], a[232:235], a[40:43], v[80:95]
    ds_read_b64_tr_b16 a[224:225], v16 offset:0
    ds_read_b64_tr_b16 a[226:227], v16 offset:1024
    s_waitcnt lgkmcnt(10)
    v_mfma_f32_32x32x16_bf16 v[64:79], a[236:239], a[40:43], v[64:79]
    buffer_load_dwordx4 a[124:127], v11, s[36:39], s63 offen offset:3072 sc1
    ds_read_b64_tr_b16 a[228:229], v17 offset:0
    ds_read_b64_tr_b16 a[230:231], v17 offset:1024
    s_waitcnt vmcnt(20) lgkmcnt(10)
    v_mfma_f32_32x32x16_bf16 v[96:111], a[240:243], a[44:47], v[96:111]
    ds_read_b64_tr_b16 a[232:233], v17 offset:8192
    ds_read_b64_tr_b16 a[234:235], v17 offset:9216
    s_waitcnt lgkmcnt(10)
    v_mfma_f32_32x32x16_bf16 v[112:127], a[244:247], a[44:47], v[112:127]
    buffer_load_dwordx4 a[128:131], v11, s[36:39], s33 offen sc1
    ds_read_b64_tr_b16 a[236:237], v16 offset:8192
    ds_read_b64_tr_b16 a[238:239], v16 offset:9216
    s_waitcnt lgkmcnt(10)
    v_mfma_f32_32x32x16_bf16 v[80:95], a[248:251], a[44:47], v[80:95]
    ds_read_b64_tr_b16 a[240:241], v16 offset:2048
    ds_read_b64_tr_b16 a[242:243], v16 offset:3072
    s_waitcnt lgkmcnt(10)
    v_mfma_f32_32x32x16_bf16 v[64:79], a[252:255], a[44:47], v[64:79]
    buffer_load_dwordx4 a[132:135], v11, s[36:39], s33 offen offset:1024 sc1
    ds_read_b64_tr_b16 a[244:245], v17 offset:2048
    ds_read_b64_tr_b16 a[246:247], v17 offset:3072
    s_waitcnt vmcnt(21) lgkmcnt(10)
    v_mfma_f32_32x32x16_bf16 v[96:111], a[224:227], a[48:51], v[96:111]
    ds_read_b64_tr_b16 a[248:249], v17 offset:10240
    ds_read_b64_tr_b16 a[250:251], v17 offset:11264
    s_waitcnt lgkmcnt(10)
    v_mfma_f32_32x32x16_bf16 v[112:127], a[228:231], a[48:51], v[112:127]
    buffer_load_dwordx4 a[136:139], v11, s[36:39], s33 offen offset:2048 sc1
    ds_read_b64_tr_b16 a[252:253], v16 offset:10240
    ds_read_b64_tr_b16 a[254:255], v16 offset:11264
    s_waitcnt lgkmcnt(10)
    v_mfma_f32_32x32x16_bf16 v[80:95], a[232:235], a[48:51], v[80:95]
    ds_read_b64_tr_b16 a[224:225], v16 offset:4096
    ds_read_b64_tr_b16 a[226:227], v16 offset:5120
    s_waitcnt lgkmcnt(10)
    v_mfma_f32_32x32x16_bf16 v[64:79], a[236:239], a[48:51], v[64:79]
    buffer_load_dwordx4 a[140:143], v11, s[36:39], s33 offen offset:3072 sc1
    ds_read_b64_tr_b16 a[228:229], v17 offset:4096
    ds_read_b64_tr_b16 a[230:231], v17 offset:5120
    s_add_u32 s63, s33, 4096
    s_waitcnt vmcnt(22) lgkmcnt(10)
    v_mfma_f32_32x32x16_bf16 v[96:111], a[240:243], a[52:55], v[96:111]
    ds_read_b64_tr_b16 a[232:233], v17 offset:12288
    ds_read_b64_tr_b16 a[234:235], v17 offset:13312
    s_waitcnt lgkmcnt(10)
    v_mfma_f32_32x32x16_bf16 v[112:127], a[244:247], a[52:55], v[112:127]
    buffer_load_dwordx4 a[144:147], v11, s[36:39], s63 offen sc1
    ds_read_b64_tr_b16 a[236:237], v16 offset:12288
    ds_read_b64_tr_b16 a[238:239], v16 offset:13312
    s_waitcnt lgkmcnt(10)
    v_mfma_f32_32x32x16_bf16 v[80:95], a[248:251], a[52:55], v[80:95]
    ds_read_b64_tr_b16 a[240:241], v16 offset:6144
    ds_read_b64_tr_b16 a[242:243], v16 offset:7168
    s_waitcnt lgkmcnt(10)
    v_mfma_f32_32x32x16_bf16 v[64:79], a[252:255], a[52:55], v[64:79]
    buffer_load_dwordx4 a[148:151], v11, s[36:39], s63 offen offset:1024 sc1
    ds_read_b64_tr_b16 a[244:245], v17 offset:6144
    ds_read_b64_tr_b16 a[246:247], v17 offset:7168
    s_waitcnt vmcnt(23) lgkmcnt(10)
    v_mfma_f32_32x32x16_bf16 v[96:111], a[224:227], a[56:59], v[96:111]
    ds_read_b64_tr_b16 a[248:249], v17 offset:14336
    ds_read_b64_tr_b16 a[250:251], v17 offset:15360
    s_waitcnt lgkmcnt(10)
    v_mfma_f32_32x32x16_bf16 v[112:127], a[228:231], a[56:59], v[112:127]
    buffer_load_dwordx4 a[152:155], v11, s[36:39], s63 offen offset:2048 sc1
    ds_read_b64_tr_b16 a[252:253], v16 offset:14336
    ds_read_b64_tr_b16 a[254:255], v16 offset:15360
    s_waitcnt lgkmcnt(10)
    v_mfma_f32_32x32x16_bf16 v[80:95], a[232:235], a[56:59], v[80:95]
    ds_read_b64_tr_b16 a[224:225], v14 offset:0
    ds_read_b64_tr_b16 a[226:227], v14 offset:1024
    s_waitcnt lgkmcnt(10)
    v_mfma_f32_32x32x16_bf16 v[64:79], a[236:239], a[56:59], v[64:79]
    buffer_load_dwordx4 a[156:159], v11, s[36:39], s63 offen offset:3072 sc1
    ds_read_b64_tr_b16 a[228:229], v15 offset:0
    ds_read_b64_tr_b16 a[230:231], v15 offset:1024
    s_barrier
    s_waitcnt vmcnt(24) lgkmcnt(10)
    v_mfma_f32_32x32x16_bf16 v[96:111], a[240:243], a[60:63], v[96:111]
    ds_read_b64_tr_b16 a[232:233], v14 offset:2048
    ds_read_b64_tr_b16 a[234:235], v14 offset:3072
    s_waitcnt lgkmcnt(10)
    v_mfma_f32_32x32x16_bf16 v[112:127], a[244:247], a[60:63], v[112:127]
    buffer_load_dwordx4 a[160:163], v11, s[36:39], s34 offen sc1
    ds_read_b64_tr_b16 a[236:237], v15 offset:2048
    ds_read_b64_tr_b16 a[238:239], v15 offset:3072
    s_waitcnt lgkmcnt(10)
    v_mfma_f32_32x32x16_bf16 v[80:95], a[248:251], a[60:63], v[80:95]
    ds_read_b64_tr_b16 a[240:241], v14 offset:4096
    ds_read_b64_tr_b16 a[242:243], v14 offset:5120
    s_waitcnt lgkmcnt(10)
    v_mfma_f32_32x32x16_bf16 v[64:79], a[252:255], a[60:63], v[64:79]
    buffer_load_dwordx4 a[164:167], v11, s[36:39], s34 offen offset:1024 sc1
    ds_read_b64_tr_b16 a[244:245], v15 offset:4096
    ds_read_b64_tr_b16 a[246:247], v15 offset:5120
    s_waitcnt vmcnt(25) lgkmcnt(10)
    v_mfma_f32_32x32x16_bf16 v[96:111], a[224:227], a[64:67], v[96:111]
    ds_read_b64_tr_b16 a[248:249], v14 offset:6144
    ds_read_b64_tr_b16 a[250:251], v14 offset:7168
    s_waitcnt lgkmcnt(10)
    v_mfma_f32_32x32x16_bf16 v[112:127], a[228:231], a[64:67], v[112:127]
    buffer_load_dwordx4 a[168:171], v11, s[36:39], s34 offen offset:2048 sc1
    ds_read_b64_tr_b16 a[252:253], v15 offset:6144
    ds_read_b64_tr_b16 a[254:255], v15 offset:7168
    s_waitcnt vmcnt(25) lgkmcnt(10)
    v_mfma_f32_32x32x16_bf16 v[96:111], a[232:235], a[68:71], v[96:111]
    ds_read_b64_tr_b16 a[224:225], v14 offset:8192
    ds_read_b64_tr_b16 a[226:227], v14 offset:9216
    s_waitcnt lgkmcnt(10)
    v_mfma_f32_32x32x16_bf16 v[112:127], a[236:239], a[68:71], v[112:127]
    buffer_load_dwordx4 a[172:175], v11, s[36:39], s34 offen offset:3072 sc1
    ds_read_b64_tr_b16 a[228:229], v15 offset:8192
    ds_read_b64_tr_b16 a[230:231], v15 offset:9216
    s_add_u32 s63, s34, 4096
    s_waitcnt vmcnt(25) lgkmcnt(10)
    v_mfma_f32_32x32x16_bf16 v[96:111], a[240:243], a[72:75], v[96:111]
    ds_read_b64_tr_b16 a[232:233], v14 offset:10240
    ds_read_b64_tr_b16 a[234:235], v14 offset:11264
    s_waitcnt lgkmcnt(10)
    v_mfma_f32_32x32x16_bf16 v[112:127], a[244:247], a[72:75], v[112:127]
    buffer_load_dwordx4 a[176:179], v11, s[36:39], s63 offen sc1
    ds_read_b64_tr_b16 a[236:237], v15 offset:10240
    ds_read_b64_tr_b16 a[238:239], v15 offset:11264
    s_waitcnt vmcnt(25) lgkmcnt(10)
    v_mfma_f32_32x32x16_bf16 v[96:111], a[248:251], a[76:79], v[96:111]
    ds_read_b64_tr_b16 a[240:241], v14 offset:12288
    ds_read_b64_tr_b16 a[242:243], v14 offset:13312
    s_waitcnt lgkmcnt(10)
    v_mfma_f32_32x32x16_bf16 v[112:127], a[252:255], a[76:79], v[112:127]
    buffer_load_dwordx4 a[180:183], v11, s[36:39], s63 offen offset:1024 sc1
    ds_read_b64_tr_b16 a[244:245], v15 offset:12288
    ds_read_b64_tr_b16 a[246:247], v15 offset:13312
    s_waitcnt vmcnt(25) lgkmcnt(10)
    v_mfma_f32_32x32x16_bf16 v[96:111], a[224:227], a[80:83], v[96:111]
    ds_read_b64_tr_b16 a[248:249], v14 offset:14336
    ds_read_b64_tr_b16 a[250:251], v14 offset:15360
    s_waitcnt lgkmcnt(10)
    v_mfma_f32_32x32x16_bf16 v[112:127], a[228:231], a[80:83], v[112:127]
    buffer_load_dwordx4 a[184:187], v11, s[36:39], s63 offen offset:2048 sc1
    ds_read_b64_tr_b16 a[252:253], v15 offset:14336
    ds_read_b64_tr_b16 a[254:255], v15 offset:15360
    s_waitcnt vmcnt(25) lgkmcnt(10)
    v_mfma_f32_32x32x16_bf16 v[96:111], a[232:235], a[84:87], v[96:111]
    ds_read_b64_tr_b16 a[224:225], v16 offset:16384
    ds_read_b64_tr_b16 a[226:227], v16 offset:17408
    s_waitcnt lgkmcnt(10)
    v_mfma_f32_32x32x16_bf16 v[112:127], a[236:239], a[84:87], v[112:127]
    buffer_load_dwordx4 a[188:191], v11, s[36:39], s63 offen offset:3072 sc1
    ds_read_b64_tr_b16 a[228:229], v17 offset:16384
    ds_read_b64_tr_b16 a[230:231], v17 offset:17408
    s_waitcnt vmcnt(25) lgkmcnt(10)
    v_mfma_f32_32x32x16_bf16 v[96:111], a[240:243], a[88:91], v[96:111]
    ds_read_b64_tr_b16 a[232:233], v16 offset:18432
    ds_read_b64_tr_b16 a[234:235], v16 offset:19456
    s_waitcnt lgkmcnt(10)
    v_mfma_f32_32x32x16_bf16 v[112:127], a[244:247], a[88:91], v[112:127]
    buffer_load_dwordx4 a[192:195], v11, s[36:39], s35 offen sc1
    ds_read_b64_tr_b16 a[236:237], v17 offset:18432
    ds_read_b64_tr_b16 a[238:239], v17 offset:19456
    s_add_u32 m0, s60, 32768
    s_waitcnt vmcnt(25) lgkmcnt(10)
    v_mfma_f32_32x32x16_bf16 v[96:111], a[248:251], a[92:95], v[96:111]
    ds_read_b64_tr_b16 a[240:241], v16 offset:20480
    ds_read_b64_tr_b16 a[242:243], v16 offset:21504
    s_waitcnt lgkmcnt(10)
    v_mfma_f32_32x32x16_bf16 v[112:127], a[252:255], a[92:95], v[112:127]
    buffer_load_dwordx4 v10, s[40:43], s7 offen lds
    ds_read_b64_tr_b16 a[244:245], v17 offset:20480
    ds_read_b64_tr_b16 a[246:247], v17 offset:21504
    s_add_u32 m0, s60, 33792
    s_add_u32 s66, s7, 16384
    s_waitcnt vmcnt(25) lgkmcnt(10)
    v_mfma_f32_32x32x16_bf16 v[96:111], a[224:227], a[96:99], v[96:111]
    ds_read_b64_tr_b16 a[248:249], v16 offset:22528
    ds_read_b64_tr_b16 a[250:251], v16 offset:23552
    s_waitcnt lgkmcnt(10)
    v_mfma_f32_32x32x16_bf16 v[112:127], a[228:231], a[96:99], v[112:127]
    buffer_load_dwordx4 v10, s[40:43], s66 offen lds
    ds_read_b64_tr_b16 a[252:253], v17 offset:22528
    ds_read_b64_tr_b16 a[254:255], v17 offset:23552
    s_waitcnt vmcnt(25) lgkmcnt(10)
    v_mfma_f32_32x32x16_bf16 v[96:111], a[232:235], a[100:103], v[96:111]
    ds_read_b64_tr_b16 a[224:225], v16 offset:24576
    ds_read_b64_tr_b16 a[226:227], v16 offset:25600
    s_waitcnt lgkmcnt(10)
    v_mfma_f32_32x32x16_bf16 v[112:127], a[236:239], a[100:103], v[112:127]
    buffer_load_dwordx4 a[196:199], v11, s[36:39], s35 offen offset:1024 sc1
    ds_read_b64_tr_b16 a[228:229], v17 offset:24576
    ds_read_b64_tr_b16 a[230:231], v17 offset:25600
    s_waitcnt vmcnt(25) lgkmcnt(10)
    v_mfma_f32_32x32x16_bf16 v[96:111], a[240:243], a[104:107], v[96:111]
    ds_read_b64_tr_b16 a[232:233], v16 offset:26624
    ds_read_b64_tr_b16 a[234:235], v16 offset:27648
    s_waitcnt lgkmcnt(10)
    v_mfma_f32_32x32x16_bf16 v[112:127], a[244:247], a[104:107], v[112:127]
    buffer_load_dwordx4 a[200:203], v11, s[36:39], s35 offen offset:2048 sc1
    ds_read_b64_tr_b16 a[236:237], v17 offset:26624
    ds_read_b64_tr_b16 a[238:239], v17 offset:27648
    s_add_u32 m0, s60, 40960
    s_add_u32 s66, s7, 131072
    s_waitcnt vmcnt(25) lgkmcnt(10)
    v_mfma_f32_32x32x16_bf16 v[96:111], a[248:251], a[108:111], v[96:111]
    ds_read_b64_tr_b16 a[240:241], v16 offset:28672
    ds_read_b64_tr_b16 a[242:243], v16 offset:29696
    s_waitcnt lgkmcnt(10)
    v_mfma_f32_32x32x16_bf16 v[112:127], a[252:255], a[108:111], v[112:127]
    buffer_load_dwordx4 v10, s[40:43], s66 offen lds
    ds_read_b64_tr_b16 a[244:245], v17 offset:28672
    ds_read_b64_tr_b16 a[246:247], v17 offset:29696
    s_add_u32 m0, s60, 41984
    s_add_u32 s66, s7, 147456
    s_waitcnt vmcnt(25) lgkmcnt(10)
    v_mfma_f32_32x32x16_bf16 v[96:111], a[224:227], a[112:115], v[96:111]
    ds_read_b64_tr_b16 a[248:249], v16 offset:30720
    ds_read_b64_tr_b16 a[250:251], v16 offset:31744
    s_waitcnt lgkmcnt(10)
    v_mfma_f32_32x32x16_bf16 v[112:127], a[228:231], a[112:115], v[112:127]
    buffer_load_dwordx4 v10, s[40:43], s66 offen lds
    ds_read_b64_tr_b16 a[252:253], v17 offset:30720
    ds_read_b64_tr_b16 a[254:255], v17 offset:31744
    s_waitcnt vmcnt(25) lgkmcnt(10)
    v_mfma_f32_32x32x16_bf16 v[96:111], a[232:235], a[116:119], v[96:111]
    ds_read_b64_tr_b16 a[224:225], v12 offset:0
    ds_read_b64_tr_b16 a[226:227], v12 offset:1024
    s_waitcnt lgkmcnt(10)
    v_mfma_f32_32x32x16_bf16 v[112:127], a[236:239], a[116:119], v[112:127]
    buffer_load_dwordx4 a[204:207], v11, s[36:39], s35 offen offset:3072 sc1
    ds_read_b64_tr_b16 a[228:229], v13 offset:0
    ds_read_b64_tr_b16 a[230:231], v13 offset:1024
    s_add_u32 s63, s35, 4096
    s_waitcnt vmcnt(25) lgkmcnt(10)
    v_mfma_f32_32x32x16_bf16 v[96:111], a[240:243], a[120:123], v[96:111]
    ds_read_b64_tr_b16 a[232:233], v12 offset:2048
    ds_read_b64_tr_b16 a[234:235], v12 offset:3072
    s_waitcnt lgkmcnt(10)
    v_mfma_f32_32x32x16_bf16 v[112:127], a[244:247], a[120:123], v[112:127]
    buffer_load_dwordx4 a[208:211], v11, s[36:39], s63 offen sc1
    ds_read_b64_tr_b16 a[236:237], v13 offset:2048
    ds_read_b64_tr_b16 a[238:239], v13 offset:3072
    s_add_u32 m0, s60, 114688
    s_waitcnt vmcnt(25) lgkmcnt(10)
    v_mfma_f32_32x32x16_bf16 v[96:111], a[248:251], a[124:127], v[96:111]
    ds_read_b64_tr_b16 a[240:241], v12 offset:4096
    ds_read_b64_tr_b16 a[242:243], v12 offset:5120
    s_waitcnt lgkmcnt(10)
    v_mfma_f32_32x32x16_bf16 v[112:127], a[252:255], a[124:127], v[112:127]
    buffer_load_dwordx4 v10, s[40:43], s8 offen lds
    ds_read_b64_tr_b16 a[244:245], v13 offset:4096
    ds_read_b64_tr_b16 a[246:247], v13 offset:5120
    s_add_u32 m0, s60, 115712
    s_add_u32 s66, s8, 16384
    s_waitcnt vmcnt(25) lgkmcnt(10)
    v_mfma_f32_32x32x16_bf16 v[96:111], a[224:227], a[128:131], v[96:111]
    ds_read_b64_tr_b16 a[248:249], v12 offset:6144
    ds_read_b64_tr_b16 a[250:251], v12 offset:7168
    s_waitcnt lgkmcnt(10)
    v_mfma_f32_32x32x16_bf16 v[112:127], a[228:231], a[128:131], v[112:127]
    buffer_load_dwordx4 v10, s[40:43], s66 offen lds
    ds_read_b64_tr_b16 a[252:253], v13 offset:6144
    ds_read_b64_tr_b16 a[254:255], v13 offset:7168
    s_waitcnt vmcnt(25) lgkmcnt(10)
    v_mfma_f32_32x32x16_bf16 v[96:111], a[232:235], a[132:135], v[96:111]
    ds_read_b64_tr_b16 a[224:225], v12 offset:8192
    ds_read_b64_tr_b16 a[226:227], v12 offset:9216
    s_waitcnt lgkmcnt(10)
    v_mfma_f32_32x32x16_bf16 v[112:127], a[236:239], a[132:135], v[112:127]
    buffer_load_dwordx4 a[212:215], v11, s[36:39], s63 offen offset:1024 sc1
    ds_read_b64_tr_b16 a[228:229], v13 offset:8192
    ds_read_b64_tr_b16 a[230:231], v13 offset:9216
    s_waitcnt vmcnt(25) lgkmcnt(10)
    v_mfma_f32_32x32x16_bf16 v[96:111], a[240:243], a[136:139], v[96:111]
    ds_read_b64_tr_b16 a[232:233], v12 offset:10240
    ds_read_b64_tr_b16 a[234:235], v12 offset:11264
    s_waitcnt lgkmcnt(10)
    v_mfma_f32_32x32x16_bf16 v[112:127], a[244:247], a[136:139], v[112:127]
    buffer_load_dwordx4 a[216:219], v11, s[36:39], s63 offen offset:2048 sc1
    ds_read_b64_tr_b16 a[236:237], v13 offset:10240
    ds_read_b64_tr_b16 a[238:239], v13 offset:11264
    s_add_u32 m0, s60, 122880
    s_add_u32 s66, s8, 131072
    s_waitcnt vmcnt(25) lgkmcnt(10)
    v_mfma_f32_32x32x16_bf16 v[96:111], a[248:251], a[140:143], v[96:111]
    ds_read_b64_tr_b16 a[240:241], v12 offset:12288
    ds_read_b64_tr_b16 a[242:243], v12 offset:13312
    s_waitcnt lgkmcnt(10)
    v_mfma_f32_32x32x16_bf16 v[112:127], a[252:255], a[140:143], v[112:127]
    buffer_load_dwordx4 v10, s[40:43], s66 offen lds
    ds_read_b64_tr_b16 a[244:245], v13 offset:12288
    ds_read_b64_tr_b16 a[246:247], v13 offset:13312
    s_add_u32 m0, s60, 123904
    s_add_u32 s66, s8, 147456
    s_waitcnt vmcnt(25) lgkmcnt(10)
    v_mfma_f32_32x32x16_bf16 v[96:111], a[224:227], a[144:147], v[96:111]
    ds_read_b64_tr_b16 a[248:249], v12 offset:14336
    ds_read_b64_tr_b16 a[250:251], v12 offset:15360
    s_waitcnt lgkmcnt(10)
    v_mfma_f32_32x32x16_bf16 v[112:127], a[228:231], a[144:147], v[112:127]
    buffer_load_dwordx4 v10, s[40:43], s66 offen lds
    ds_read_b64_tr_b16 a[252:253], v13 offset:14336
    ds_read_b64_tr_b16 a[254:255], v13 offset:15360
    s_waitcnt vmcnt(25) lgkmcnt(10)
    v_mfma_f32_32x32x16_bf16 v[96:111], a[232:235], a[148:151], v[96:111]
    s_barrier
    ds_read_b64_tr_b16 a[224:225], v14 offset:16384
    ds_read_b64_tr_b16 a[226:227], v14 offset:17408
    s_waitcnt lgkmcnt(10)
    v_mfma_f32_32x32x16_bf16 v[112:127], a[236:239], a[148:151], v[112:127]
    buffer_load_dwordx4 a[220:223], v11, s[36:39], s63 offen offset:3072 sc1
    ds_read_b64_tr_b16 a[228:229], v15 offset:16384
    ds_read_b64_tr_b16 a[230:231], v15 offset:17408
    s_add_u32 m0, s60, 49152
    s_waitcnt vmcnt(25) lgkmcnt(10)
    v_mfma_f32_32x32x16_bf16 v[96:111], a[240:243], a[152:155], v[96:111]
    ds_read_b64_tr_b16 a[232:233], v14 offset:18432
    ds_read_b64_tr_b16 a[234:235], v14 offset:19456
    s_waitcnt lgkmcnt(10)
    v_mfma_f32_32x32x16_bf16 v[112:127], a[244:247], a[152:155], v[112:127]
    buffer_load_dwordx4 v10, s[40:43], s9 offen lds
    ds_read_b64_tr_b16 a[236:237], v15 offset:18432
    ds_read_b64_tr_b16 a[238:239], v15 offset:19456
    s_add_u32 m0, s60, 50176
    s_add_u32 s66, s9, 16384
    s_waitcnt vmcnt(25) lgkmcnt(10)
    v_mfma_f32_32x32x16_bf16 v[96:111], a[248:251], a[156:159], v[96:111]
    ds_read_b64_tr_b16 a[240:241], v14 offset:20480
    ds_read_b64_tr_b16 a[242:243], v14 offset:21504
    s_waitcnt lgkmcnt(10)
    v_mfma_f32_32x32x16_bf16 v[112:127], a[252:255], a[156:159], v[112:127]
    buffer_load_dwordx4 v10, s[40:43], s66 offen lds
    ds_read_b64_tr_b16 a[244:245], v15 offset:20480
    ds_read_b64_tr_b16 a[246:247], v15 offset:21504
    s_add_u32 m0, s60, 57344
    s_add_u32 s66, s9, 131072
    s_waitcnt vmcnt(25) lgkmcnt(10)
    v_mfma_f32_32x32x16_bf16 v[96:111], a[224:227], a[160:163], v[96:111]
    ds_read_b64_tr_b16 a[248:249], v14 offset:22528
    ds_read_b64_tr_b16 a[250:251], v14 offset:23552
    s_waitcnt lgkmcnt(10)
    v_mfma_f32_32x32x16_bf16 v[112:127], a[228:231], a[160:163], v[112:127]
    buffer_load_dwordx4 v10, s[40:43], s66 offen lds
    ds_read_b64_tr_b16 a[252:253], v15 offset:22528
    ds_read_b64_tr_b16 a[254:255], v15 offset:23552
    s_add_u32 m0, s60, 58368
    s_add_u32 s66, s9, 147456
    s_waitcnt vmcnt(25) lgkmcnt(10)
    v_mfma_f32_32x32x16_bf16 v[96:111], a[232:235], a[164:167], v[96:111]
    ds_read_b64_tr_b16 a[224:225], v14 offset:24576
    ds_read_b64_tr_b16 a[226:227], v14 offset:25600
    s_waitcnt lgkmcnt(10)
    v_mfma_f32_32x32x16_bf16 v[112:127], a[236:239], a[164:167], v[112:127]
    buffer_load_dwordx4 v10, s[40:43], s66 offen lds
    ds_read_b64_tr_b16 a[228:229], v15 offset:24576
    ds_read_b64_tr_b16 a[230:231], v15 offset:25600
    s_add_u32 m0, s60, 131072
    s_waitcnt vmcnt(25) lgkmcnt(10)
    v_mfma_f32_32x32x16_bf16 v[96:111], a[240:243], a[168:171], v[96:111]
    ds_read_b64_tr_b16 a[232:233], v14 offset:26624
    ds_read_b64_tr_b16 a[234:235], v14 offset:27648
    s_waitcnt lgkmcnt(10)
    v_mfma_f32_32x32x16_bf16 v[112:127], a[244:247], a[168:171], v[112:127]
    buffer_load_dwordx4 v10, s[40:43], s10 offen lds
    ds_read_b64_tr_b16 a[236:237], v15 offset:26624
    ds_read_b64_tr_b16 a[238:239], v15 offset:27648
    s_add_u32 m0, s60, 132096
    s_add_u32 s66, s10, 16384
    s_waitcnt vmcnt(25) lgkmcnt(10)
    v_mfma_f32_32x32x16_bf16 v[96:111], a[248:251], a[172:175], v[96:111]
    ds_read_b64_tr_b16 a[240:241], v14 offset:28672
    ds_read_b64_tr_b16 a[242:243], v14 offset:29696
    s_waitcnt lgkmcnt(10)
    v_mfma_f32_32x32x16_bf16 v[112:127], a[252:255], a[172:175], v[112:127]
    buffer_load_dwordx4 v10, s[40:43], s66 offen lds
    ds_read_b64_tr_b16 a[244:245], v15 offset:28672
    ds_read_b64_tr_b16 a[246:247], v15 offset:29696
    s_add_u32 m0, s60, 139264
    s_add_u32 s66, s10, 131072
    s_waitcnt vmcnt(25) lgkmcnt(10)
    v_mfma_f32_32x32x16_bf16 v[96:111], a[224:227], a[176:179], v[96:111]
    ds_read_b64_tr_b16 a[248:249], v14 offset:30720
    ds_read_b64_tr_b16 a[250:251], v14 offset:31744
    s_waitcnt lgkmcnt(10)
    v_mfma_f32_32x32x16_bf16 v[112:127], a[228:231], a[176:179], v[112:127]
    buffer_load_dwordx4 v10, s[40:43], s66 offen lds
    ds_read_b64_tr_b16 a[252:253], v15 offset:30720
    ds_read_b64_tr_b16 a[254:255], v15 offset:31744
    s_add_u32 m0, s60, 140288
    s_add_u32 s66, s10, 147456
    s_waitcnt vmcnt(25) lgkmcnt(10)
    v_mfma_f32_32x32x16_bf16 v[96:111], a[232:235], a[180:183], v[96:111]
    ds_read_b64_tr_b16 a[224:225], v14 offset:32768
    ds_read_b64_tr_b16 a[226:227], v14 offset:33792
    s_waitcnt lgkmcnt(10)
    v_mfma_f32_32x32x16_bf16 v[112:127], a[236:239], a[180:183], v[112:127]
    buffer_load_dwordx4 v10, s[40:43], s66 offen lds
    ds_read_b64_tr_b16 a[228:229], v15 offset:32768
    ds_read_b64_tr_b16 a[230:231], v15 offset:33792
    s_waitcnt vmcnt(25) lgkmcnt(10)
    v_mfma_f32_32x32x16_bf16 v[96:111], a[240:243], a[184:187], v[96:111]
    ds_read_b64_tr_b16 a[232:233], v14 offset:34816
    ds_read_b64_tr_b16 a[234:235], v14 offset:35840
    s_waitcnt lgkmcnt(10)
    v_mfma_f32_32x32x16_bf16 v[112:127], a[244:247], a[184:187], v[112:127]
    ds_read_b64_tr_b16 a[236:237], v15 offset:34816
    ds_read_b64_tr_b16 a[238:239], v15 offset:35840
    s_waitcnt vmcnt(24) lgkmcnt(10)
    v_mfma_f32_32x32x16_bf16 v[96:111], a[248:251], a[188:191], v[96:111]
    ds_read_b64_tr_b16 a[240:241], v14 offset:36864
    ds_read_b64_tr_b16 a[242:243], v14 offset:37888
    s_waitcnt lgkmcnt(10)
    v_mfma_f32_32x32x16_bf16 v[112:127], a[252:255], a[188:191], v[112:127]
    ds_read_b64_tr_b16 a[244:245], v15 offset:36864
    ds_read_b64_tr_b16 a[246:247], v15 offset:37888
    s_waitcnt vmcnt(23) lgkmcnt(10)
    v_mfma_f32_32x32x16_bf16 v[96:111], a[224:227], a[192:195], v[96:111]
    ds_read_b64_tr_b16 a[248:249], v14 offset:38912
    ds_read_b64_tr_b16 a[250:251], v14 offset:39936
    s_waitcnt lgkmcnt(10)
    v_mfma_f32_32x32x16_bf16 v[112:127], a[228:231], a[192:195], v[112:127]
    ds_read_b64_tr_b16 a[252:253], v15 offset:38912
    ds_read_b64_tr_b16 a[254:255], v15 offset:39936
    s_waitcnt vmcnt(20) lgkmcnt(10)
    v_mfma_f32_32x32x16_bf16 v[96:111], a[232:235], a[196:199], v[96:111]
    ds_read_b64_tr_b16 a[224:225], v14 offset:40960
    ds_read_b64_tr_b16 a[226:227], v14 offset:41984
    s_waitcnt lgkmcnt(10)
    v_mfma_f32_32x32x16_bf16 v[112:127], a[236:239], a[196:199], v[112:127]
    ds_read_b64_tr_b16 a[228:229], v15 offset:40960
    ds_read_b64_tr_b16 a[230:231], v15 offset:41984
    s_waitcnt vmcnt(19) lgkmcnt(10)
    v_mfma_f32_32x32x16_bf16 v[96:111], a[240:243], a[200:203], v[96:111]
    ds_read_b64_tr_b16 a[232:233], v14 offset:43008
    ds_read_b64_tr_b16 a[234:235], v14 offset:44032
    s_waitcnt lgkmcnt(10)
    v_mfma_f32_32x32x16_bf16 v[112:127], a[244:247], a[200:203], v[112:127]
    ds_read_b64_tr_b16 a[236:237], v15 offset:43008
    ds_read_b64_tr_b16 a[238:239], v15 offset:44032
    s_waitcnt vmcnt(16) lgkmcnt(10)
    v_mfma_f32_32x32x16_bf16 v[96:111], a[248:251], a[204:207], v[96:111]
    ds_read_b64_tr_b16 a[240:241], v14 offset:45056
    ds_read_b64_tr_b16 a[242:243], v14 offset:46080
    s_waitcnt lgkmcnt(10)
    v_mfma_f32_32x32x16_bf16 v[112:127], a[252:255], a[204:207], v[112:127]
    ds_read_b64_tr_b16 a[244:245], v15 offset:45056
    ds_read_b64_tr_b16 a[246:247], v15 offset:46080
    s_waitcnt vmcnt(15) lgkmcnt(10)
    v_mfma_f32_32x32x16_bf16 v[96:111], a[224:227], a[208:211], v[96:111]
    ds_read_b64_tr_b16 a[248:249], v14 offset:47104
    ds_read_b64_tr_b16 a[250:251], v14 offset:48128
    s_waitcnt lgkmcnt(10)
    v_mfma_f32_32x32x16_bf16 v[112:127], a[228:231], a[208:211], v[112:127]
    ds_read_b64_tr_b16 a[252:253], v15 offset:47104
    ds_read_b64_tr_b16 a[254:255], v15 offset:48128
    s_waitcnt vmcnt(12) lgkmcnt(10)
    v_mfma_f32_32x32x16_bf16 v[96:111], a[232:235], a[212:215], v[96:111]
    ds_read_b64_tr_b16 a[224:225], v13 offset:16384
    ds_read_b64_tr_b16 a[226:227], v13 offset:17408
    s_waitcnt lgkmcnt(10)
    v_mfma_f32_32x32x16_bf16 v[112:127], a[236:239], a[212:215], v[112:127]
    ds_read_b64_tr_b16 a[228:229], v13 offset:18432
    ds_read_b64_tr_b16 a[230:231], v13 offset:19456
    s_waitcnt vmcnt(11) lgkmcnt(10)
    v_mfma_f32_32x32x16_bf16 v[96:111], a[240:243], a[216:219], v[96:111]
    ds_read_b64_tr_b16 a[232:233], v13 offset:20480
    ds_read_b64_tr_b16 a[234:235], v13 offset:21504
    s_waitcnt lgkmcnt(10)
    v_mfma_f32_32x32x16_bf16 v[112:127], a[244:247], a[216:219], v[112:127]
    ds_read_b64_tr_b16 a[236:237], v13 offset:22528
    ds_read_b64_tr_b16 a[238:239], v13 offset:23552
    s_waitcnt vmcnt(8) lgkmcnt(10)
    v_mfma_f32_32x32x16_bf16 v[96:111], a[248:251], a[220:223], v[96:111]
    ds_read_b64_tr_b16 a[240:241], v13 offset:24576
    ds_read_b64_tr_b16 a[242:243], v13 offset:25600
    s_waitcnt lgkmcnt(10)
    v_mfma_f32_32x32x16_bf16 v[112:127], a[252:255], a[220:223], v[112:127]
    ds_read_b64_tr_b16 a[244:245], v13 offset:26624
    ds_read_b64_tr_b16 a[246:247], v13 offset:27648
    s_waitcnt lgkmcnt(10)
    v_mfma_f32_32x32x16_bf16 v[80:95], a[224:227], a[64:67], v[80:95]
    s_xor_b32 s67, s52, 2
    s_lshl_b32 s67, s67, 16
    s_add_u32 s67, s67, s64
    s_add_u32 s67, s67, 32768
    ds_read_b64_tr_b16 a[248:249], v13 offset:28672
    ds_read_b64_tr_b16 a[250:251], v13 offset:29696
    s_waitcnt lgkmcnt(10)
    v_mfma_f32_32x32x16_bf16 v[80:95], a[228:231], a[68:71], v[80:95]
    v_cvt_pk_bf16_f32 v172, v96, v97
    v_cvt_pk_bf16_f32 v173, v98, v99
    v_cvt_pk_bf16_f32 v174, v100, v101
    ds_read_b64_tr_b16 a[252:253], v13 offset:30720
    ds_read_b64_tr_b16 a[254:255], v13 offset:31744
    s_waitcnt lgkmcnt(10)
    v_mfma_f32_32x32x16_bf16 v[80:95], a[232:235], a[72:75], v[80:95]
    buffer_store_dwordx4 v[172:175], v11, s[36:39], s67 offen sc1
    s_waitcnt vmcnt(7)
    s_waitcnt vmcnt(5)
    s_waitcnt vmcnt(3)
    s_waitcnt vmcnt(1)
    s_barrier
    ds_read_b64_tr_b16 a[224:225], v13 offset:32768
    ds_read_b64_tr_b16 a[226:227], v13 offset:33792
    s_waitcnt lgkmcnt(10)
    v_mfma_f32_32x32x16_bf16 v[80:95], a[236:239], a[76:79], v[80:95]
    v_cvt_pk_bf16_f32 v176, v102, v103
    v_cvt_pk_bf16_f32 v177, v104, v105
    v_cvt_pk_bf16_f32 v178, v106, v107
    ds_read_b64_tr_b16 a[228:229], v13 offset:34816
    ds_read_b64_tr_b16 a[230:231], v13 offset:35840
    s_waitcnt lgkmcnt(10)
    v_mfma_f32_32x32x16_bf16 v[80:95], a[240:243], a[80:83], v[80:95]
    buffer_store_dwordx4 v[176:179], v11, s[36:39], s67 offen offset:1024 sc1
    ds_read_b64_tr_b16 a[232:233], v13 offset:36864
    ds_read_b64_tr_b16 a[234:235], v13 offset:37888
    s_waitcnt lgkmcnt(10)
    v_mfma_f32_32x32x16_bf16 v[80:95], a[244:247], a[84:87], v[80:95]
    v_cvt_pk_bf16_f32 v180, v108, v109
    v_cvt_pk_bf16_f32 v181, v110, v111
    ds_read_b64_tr_b16 a[236:237], v13 offset:38912
    ds_read_b64_tr_b16 a[238:239], v13 offset:39936
    s_waitcnt lgkmcnt(10)
    v_mfma_f32_32x32x16_bf16 v[80:95], a[248:251], a[88:91], v[80:95]
    buffer_store_dwordx4 v[180:183], v11, s[36:39], s67 offen offset:2048 sc1
    ds_read_b64_tr_b16 a[240:241], v13 offset:40960
    ds_read_b64_tr_b16 a[242:243], v13 offset:41984
    s_waitcnt lgkmcnt(10)
    v_mfma_f32_32x32x16_bf16 v[80:95], a[252:255], a[92:95], v[80:95]
    s_xor_b32 s67, s52, 3
    s_lshl_b32 s67, s67, 16
    s_add_u32 s67, s67, s64
    s_add_u32 s67, s67, 49152
    ds_read_b64_tr_b16 a[244:245], v13 offset:43008
    ds_read_b64_tr_b16 a[246:247], v13 offset:44032
    s_waitcnt lgkmcnt(10)
    v_mfma_f32_32x32x16_bf16 v[80:95], a[224:227], a[96:99], v[80:95]
    v_cvt_pk_bf16_f32 v184, v112, v113
    v_cvt_pk_bf16_f32 v185, v114, v115
    v_cvt_pk_bf16_f32 v186, v116, v117
    ds_read_b64_tr_b16 a[248:249], v13 offset:45056
    ds_read_b64_tr_b16 a[250:251], v13 offset:46080
    s_waitcnt lgkmcnt(10)
    v_mfma_f32_32x32x16_bf16 v[80:95], a[228:231], a[100:103], v[80:95]
    buffer_store_dwordx4 v[184:187], v11, s[36:39], s67 offen sc1
    ds_read_b64_tr_b16 a[252:253], v13 offset:47104
    ds_read_b64_tr_b16 a[254:255], v13 offset:48128
    s_waitcnt lgkmcnt(10)
    v_mfma_f32_32x32x16_bf16 v[80:95], a[232:235], a[104:107], v[80:95]
    v_cvt_pk_bf16_f32 v188, v118, v119
    v_cvt_pk_bf16_f32 v189, v120, v121
    v_cvt_pk_bf16_f32 v190, v122, v123
    ds_read_b64_tr_b16 a[224:225], v15 offset:49152
    ds_read_b64_tr_b16 a[226:227], v15 offset:50176
    s_waitcnt lgkmcnt(10)
    v_mfma_f32_32x32x16_bf16 v[80:95], a[236:239], a[108:111], v[80:95]
    buffer_store_dwordx4 v[188:191], v11, s[36:39], s67 offen offset:1024 sc1
    ds_read_b64_tr_b16 a[228:229], v15 offset:51200
    ds_read_b64_tr_b16 a[230:231], v15 offset:52224
    s_waitcnt lgkmcnt(10)
    v_mfma_f32_32x32x16_bf16 v[80:95], a[240:243], a[112:115], v[80:95]
    v_cvt_pk_bf16_f32 v192, v124, v125
    v_cvt_pk_bf16_f32 v193, v126, v127
    ds_read_b64_tr_b16 a[232:233], v15 offset:53248
    ds_read_b64_tr_b16 a[234:235], v15 offset:54272
    s_waitcnt lgkmcnt(10)
    v_mfma_f32_32x32x16_bf16 v[80:95], a[244:247], a[116:119], v[80:95]
    buffer_store_dwordx4 v[192:195], v11, s[36:39], s67 offen offset:2048 sc1
    ds_read_b64_tr_b16 a[236:237], v15 offset:55296
    ds_read_b64_tr_b16 a[238:239], v15 offset:56320
    s_waitcnt lgkmcnt(10)
    v_mfma_f32_32x32x16_bf16 v[80:95], a[248:251], a[120:123], v[80:95]
    ds_read_b64_tr_b16 a[240:241], v15 offset:57344
    ds_read_b64_tr_b16 a[242:243], v15 offset:58368
    s_waitcnt lgkmcnt(10)
    v_mfma_f32_32x32x16_bf16 v[80:95], a[252:255], a[124:127], v[80:95]
    ds_read_b64_tr_b16 a[244:245], v15 offset:59392
    ds_read_b64_tr_b16 a[246:247], v15 offset:60416
    s_waitcnt lgkmcnt(10)
    v_mfma_f32_32x32x16_bf16 v[80:95], a[224:227], a[128:131], v[80:95]
    ds_read_b64_tr_b16 a[248:249], v15 offset:61440
    ds_read_b64_tr_b16 a[250:251], v15 offset:62464
    s_waitcnt lgkmcnt(10)
    v_mfma_f32_32x32x16_bf16 v[80:95], a[228:231], a[132:135], v[80:95]
    ds_read_b64_tr_b16 a[252:253], v15 offset:63488
    ds_read_b64_tr_b16 a[254:255], v15 offset:64512
    s_waitcnt lgkmcnt(10)
    v_mfma_f32_32x32x16_bf16 v[80:95], a[232:235], a[136:139], v[80:95]
    ds_read_b64_tr_b16 a[224:225], v13 offset:49152
    ds_read_b64_tr_b16 a[226:227], v13 offset:50176
    s_waitcnt lgkmcnt(10)
    v_mfma_f32_32x32x16_bf16 v[80:95], a[236:239], a[140:143], v[80:95]
    ds_read_b64_tr_b16 a[228:229], v13 offset:51200
    ds_read_b64_tr_b16 a[230:231], v13 offset:52224
    s_waitcnt lgkmcnt(10)
    v_mfma_f32_32x32x16_bf16 v[80:95], a[240:243], a[144:147], v[80:95]
    ds_read_b64_tr_b16 a[232:233], v13 offset:53248
    ds_read_b64_tr_b16 a[234:235], v13 offset:54272
    s_waitcnt lgkmcnt(10)
    v_mfma_f32_32x32x16_bf16 v[80:95], a[244:247], a[148:151], v[80:95]
    ds_read_b64_tr_b16 a[236:237], v13 offset:55296
    ds_read_b64_tr_b16 a[238:239], v13 offset:56320
    s_waitcnt lgkmcnt(10)
    v_mfma_f32_32x32x16_bf16 v[80:95], a[248:251], a[152:155], v[80:95]
    ds_read_b64_tr_b16 a[240:241], v13 offset:57344
    ds_read_b64_tr_b16 a[242:243], v13 offset:58368
    s_waitcnt lgkmcnt(10)
    v_mfma_f32_32x32x16_bf16 v[80:95], a[252:255], a[156:159], v[80:95]
    ds_read_b64_tr_b16 a[244:245], v13 offset:59392
    ds_read_b64_tr_b16 a[246:247], v13 offset:60416
    s_waitcnt lgkmcnt(10)
    v_mfma_f32_32x32x16_bf16 v[80:95], a[224:227], a[160:163], v[80:95]
    ds_read_b64_tr_b16 a[248:249], v13 offset:61440
    ds_read_b64_tr_b16 a[250:251], v13 offset:62464
    s_waitcnt lgkmcnt(10)
    v_mfma_f32_32x32x16_bf16 v[80:95], a[228:231], a[164:167], v[80:95]
    ds_read_b64_tr_b16 a[252:253], v13 offset:63488
    ds_read_b64_tr_b16 a[254:255], v13 offset:64512
    s_waitcnt lgkmcnt(10)
    v_mfma_f32_32x32x16_bf16 v[80:95], a[232:235], a[168:171], v[80:95]
    ds_read_b64_tr_b16 a[224:225], v17 offset:0
    ds_read_b64_tr_b16 a[226:227], v17 offset:1024
    s_waitcnt lgkmcnt(10)
    v_mfma_f32_32x32x16_bf16 v[80:95], a[236:239], a[172:175], v[80:95]
    ds_read_b64_tr_b16 a[228:229], v17 offset:2048
    ds_read_b64_tr_b16 a[230:231], v17 offset:3072
    s_waitcnt lgkmcnt(10)
    v_mfma_f32_32x32x16_bf16 v[80:95], a[240:243], a[176:179], v[80:95]
    ds_read_b64_tr_b16 a[232:233], v17 offset:4096
    ds_read_b64_tr_b16 a[234:235], v17 offset:5120
    s_waitcnt lgkmcnt(10)
    v_mfma_f32_32x32x16_bf16 v[80:95], a[244:247], a[180:183], v[80:95]
    ds_read_b64_tr_b16 a[236:237], v17 offset:6144
    ds_read_b64_tr_b16 a[238:239], v17 offset:7168
    s_waitcnt lgkmcnt(10)
    v_mfma_f32_32x32x16_bf16 v[80:95], a[248:251], a[184:187], v[80:95]
    ds_read_b64_tr_b16 a[240:241], v17 offset:8192
    ds_read_b64_tr_b16 a[242:243], v17 offset:9216
    s_waitcnt lgkmcnt(10)
    v_mfma_f32_32x32x16_bf16 v[80:95], a[252:255], a[188:191], v[80:95]
    ds_read_b64_tr_b16 a[244:245], v17 offset:10240
    ds_read_b64_tr_b16 a[246:247], v17 offset:11264
    s_waitcnt lgkmcnt(10)
    v_mfma_f32_32x32x16_bf16 v[80:95], a[224:227], a[192:195], v[80:95]
    ds_read_b64_tr_b16 a[248:249], v17 offset:12288
    ds_read_b64_tr_b16 a[250:251], v17 offset:13312
    s_waitcnt lgkmcnt(10)
    v_mfma_f32_32x32x16_bf16 v[80:95], a[228:231], a[196:199], v[80:95]
    ds_read_b64_tr_b16 a[252:253], v17 offset:14336
    ds_read_b64_tr_b16 a[254:255], v17 offset:15360
    s_waitcnt lgkmcnt(10)
    v_mfma_f32_32x32x16_bf16 v[80:95], a[232:235], a[200:203], v[80:95]
    ds_read_b64_tr_b16 a[224:225], v12 offset:16384
    ds_read_b64_tr_b16 a[226:227], v12 offset:17408
    s_waitcnt lgkmcnt(10)
    v_mfma_f32_32x32x16_bf16 v[80:95], a[236:239], a[204:207], v[80:95]
    ds_read_b64_tr_b16 a[228:229], v12 offset:18432
    ds_read_b64_tr_b16 a[230:231], v12 offset:19456
    s_waitcnt lgkmcnt(10)
    v_mfma_f32_32x32x16_bf16 v[80:95], a[240:243], a[208:211], v[80:95]
    ds_read_b64_tr_b16 a[232:233], v12 offset:20480
    ds_read_b64_tr_b16 a[234:235], v12 offset:21504
    s_waitcnt lgkmcnt(10)
    v_mfma_f32_32x32x16_bf16 v[80:95], a[244:247], a[212:215], v[80:95]
    ds_read_b64_tr_b16 a[236:237], v12 offset:22528
    ds_read_b64_tr_b16 a[238:239], v12 offset:23552
    s_waitcnt lgkmcnt(10)
    v_mfma_f32_32x32x16_bf16 v[80:95], a[248:251], a[216:219], v[80:95]
    ds_read_b64_tr_b16 a[240:241], v12 offset:24576
    ds_read_b64_tr_b16 a[242:243], v12 offset:25600
    s_waitcnt lgkmcnt(10)
    v_mfma_f32_32x32x16_bf16 v[80:95], a[252:255], a[220:223], v[80:95]
    ds_read_b64_tr_b16 a[244:245], v12 offset:26624
    ds_read_b64_tr_b16 a[246:247], v12 offset:27648
    s_waitcnt lgkmcnt(10)
    v_mfma_f32_32x32x16_bf16 v[64:79], a[224:227], a[64:67], v[64:79]
    ds_read_b64_tr_b16 a[248:249], v12 offset:28672
    ds_read_b64_tr_b16 a[250:251], v12 offset:29696
    s_waitcnt lgkmcnt(10)
    v_mfma_f32_32x32x16_bf16 v[64:79], a[228:231], a[68:71], v[64:79]
    s_xor_b32 s67, s52, 1
    s_lshl_b32 s67, s67, 16
    s_add_u32 s67, s67, s64
    s_add_u32 s67, s67, 16384
    buffer_load_dword v38, v39, s[36:39], s65 offen sc1
    ds_read_b64_tr_b16 a[252:253], v12 offset:30720
    ds_read_b64_tr_b16 a[254:255], v12 offset:31744
    s_waitcnt lgkmcnt(10)
    v_mfma_f32_32x32x16_bf16 v[64:79], a[232:235], a[72:75], v[64:79]
    v_cvt_pk_bf16_f32 v160, v80, v81
    v_cvt_pk_bf16_f32 v161, v82, v83
    v_cvt_pk_bf16_f32 v162, v84, v85
    ds_read_b64_tr_b16 a[224:225], v12 offset:32768
    ds_read_b64_tr_b16 a[226:227], v12 offset:33792
    s_waitcnt lgkmcnt(10)
    v_mfma_f32_32x32x16_bf16 v[64:79], a[236:239], a[76:79], v[64:79]
    buffer_store_dwordx4 v[160:163], v11, s[36:39], s67 offen sc1
    ds_read_b64_tr_b16 a[228:229], v12 offset:34816
    ds_read_b64_tr_b16 a[230:231], v12 offset:35840
    s_waitcnt lgkmcnt(10)
    v_mfma_f32_32x32x16_bf16 v[64:79], a[240:243], a[80:83], v[64:79]
    v_cvt_pk_bf16_f32 v164, v86, v87
    v_cvt_pk_bf16_f32 v165, v88, v89
    v_cvt_pk_bf16_f32 v166, v90, v91
    ds_read_b64_tr_b16 a[232:233], v12 offset:36864
    ds_read_b64_tr_b16 a[234:235], v12 offset:37888
    s_waitcnt lgkmcnt(10)
    v_mfma_f32_32x32x16_bf16 v[64:79], a[244:247], a[84:87], v[64:79]
    buffer_store_dwordx4 v[164:167], v11, s[36:39], s67 offen offset:1024 sc1
    ds_read_b64_tr_b16 a[236:237], v12 offset:38912
    ds_read_b64_tr_b16 a[238:239], v12 offset:39936
    s_waitcnt lgkmcnt(10)
    v_mfma_f32_32x32x16_bf16 v[64:79], a[248:251], a[88:91], v[64:79]
    v_cvt_pk_bf16_f32 v168, v92, v93
    v_cvt_pk_bf16_f32 v169, v94, v95
    ds_read_b64_tr_b16 a[240:241], v12 offset:40960
    ds_read_b64_tr_b16 a[242:243], v12 offset:41984
    s_waitcnt lgkmcnt(10)
    v_mfma_f32_32x32x16_bf16 v[64:79], a[252:255], a[92:95], v[64:79]
    buffer_store_dwordx4 v[168:171], v11, s[36:39], s67 offen offset:2048 sc1
    ds_read_b64_tr_b16 a[244:245], v12 offset:43008
    ds_read_b64_tr_b16 a[246:247], v12 offset:44032
    s_waitcnt lgkmcnt(10)
    v_mfma_f32_32x32x16_bf16 v[64:79], a[224:227], a[96:99], v[64:79]
    ds_read_b64_tr_b16 a[248:249], v12 offset:45056
    ds_read_b64_tr_b16 a[250:251], v12 offset:46080
    s_waitcnt lgkmcnt(10)
    v_mfma_f32_32x32x16_bf16 v[64:79], a[228:231], a[100:103], v[64:79]
    ds_read_b64_tr_b16 a[252:253], v12 offset:47104
    ds_read_b64_tr_b16 a[254:255], v12 offset:48128
    s_waitcnt lgkmcnt(10)
    v_mfma_f32_32x32x16_bf16 v[64:79], a[232:235], a[104:107], v[64:79]
    ds_read_b64_tr_b16 a[224:225], v14 offset:49152
    ds_read_b64_tr_b16 a[226:227], v14 offset:50176
    s_waitcnt lgkmcnt(10)
    v_mfma_f32_32x32x16_bf16 v[64:79], a[236:239], a[108:111], v[64:79]
    ds_read_b64_tr_b16 a[228:229], v14 offset:51200
    ds_read_b64_tr_b16 a[230:231], v14 offset:52224
    s_waitcnt lgkmcnt(10)
    v_mfma_f32_32x32x16_bf16 v[64:79], a[240:243], a[112:115], v[64:79]
    ds_read_b64_tr_b16 a[232:233], v14 offset:53248
    ds_read_b64_tr_b16 a[234:235], v14 offset:54272
    s_waitcnt lgkmcnt(10)
    v_mfma_f32_32x32x16_bf16 v[64:79], a[244:247], a[116:119], v[64:79]
    ds_read_b64_tr_b16 a[236:237], v14 offset:55296
    ds_read_b64_tr_b16 a[238:239], v14 offset:56320
    s_waitcnt lgkmcnt(10)
    v_mfma_f32_32x32x16_bf16 v[64:79], a[248:251], a[120:123], v[64:79]
    ds_read_b64_tr_b16 a[240:241], v14 offset:57344
    ds_read_b64_tr_b16 a[242:243], v14 offset:58368
    s_waitcnt lgkmcnt(10)
    v_mfma_f32_32x32x16_bf16 v[64:79], a[252:255], a[124:127], v[64:79]
    ds_read_b64_tr_b16 a[244:245], v14 offset:59392
    ds_read_b64_tr_b16 a[246:247], v14 offset:60416
    s_waitcnt lgkmcnt(10)
    v_mfma_f32_32x32x16_bf16 v[64:79], a[224:227], a[128:131], v[64:79]
    ds_read_b64_tr_b16 a[248:249], v14 offset:61440
    ds_read_b64_tr_b16 a[250:251], v14 offset:62464
    s_waitcnt lgkmcnt(10)
    v_mfma_f32_32x32x16_bf16 v[64:79], a[228:231], a[132:135], v[64:79]
    s_waitcnt vmcnt(3)
    v_cmp_ne_u32 vcc, s70, v38
    s_mov_b32 s51, 0
    s_cbranch_vccnz L_ga_no
    s_mov_b32 s51, 1
    s_add_u32 s62, s65, 32768
    buffer_load_dwordx4 v[200:203], v11, s[36:39], s62 offen sc1
    buffer_load_dwordx4 v[204:207], v11, s[36:39], s62 offen offset:1024 sc1
    buffer_load_dwordx4 v[208:211], v11, s[36:39], s62 offen offset:2048 sc1
    s_add_u32 s62, s65, 49152
    buffer_load_dwordx4 v[212:215], v11, s[36:39], s62 offen sc1
    buffer_load_dwordx4 v[216:219], v11, s[36:39], s62 offen offset:1024 sc1
    buffer_load_dwordx4 v[220:223], v11, s[36:39], s62 offen offset:2048 sc1
    s_add_u32 s62, s65, 16384
    buffer_load_dwordx4 v[224:227], v11, s[36:39], s62 offen sc1
    buffer_load_dwordx4 v[228:231], v11, s[36:39], s62 offen offset:1024 sc1
    buffer_load_dwordx4 v[232:235], v11, s[36:39], s62 offen offset:2048 sc1
L_ga_no:
    ds_read_b64_tr_b16 a[252:253], v14 offset:63488
    ds_read_b64_tr_b16 a[254:255], v14 offset:64512
    s_waitcnt lgkmcnt(10)
    v_mfma_f32_32x32x16_bf16 v[64:79], a[232:235], a[136:139], v[64:79]
    ds_read_b64_tr_b16 a[224:225], v12 offset:49152
    ds_read_b64_tr_b16 a[226:227], v12 offset:50176
    s_waitcnt lgkmcnt(10)
    v_mfma_f32_32x32x16_bf16 v[64:79], a[236:239], a[140:143], v[64:79]
    ds_read_b64_tr_b16 a[228:229], v12 offset:51200
    ds_read_b64_tr_b16 a[230:231], v12 offset:52224
    s_waitcnt lgkmcnt(10)
    v_mfma_f32_32x32x16_bf16 v[64:79], a[240:243], a[144:147], v[64:79]
    ds_read_b64_tr_b16 a[232:233], v12 offset:53248
    ds_read_b64_tr_b16 a[234:235], v12 offset:54272
    s_waitcnt lgkmcnt(10)
    v_mfma_f32_32x32x16_bf16 v[64:79], a[244:247], a[148:151], v[64:79]
    ds_read_b64_tr_b16 a[236:237], v12 offset:55296
    ds_read_b64_tr_b16 a[238:239], v12 offset:56320
    s_waitcnt lgkmcnt(10)
    v_mfma_f32_32x32x16_bf16 v[64:79], a[248:251], a[152:155], v[64:79]
    ds_read_b64_tr_b16 a[240:241], v12 offset:57344
    ds_read_b64_tr_b16 a[242:243], v12 offset:58368
    s_waitcnt lgkmcnt(10)
    v_mfma_f32_32x32x16_bf16 v[64:79], a[252:255], a[156:159], v[64:79]
    ds_read_b64_tr_b16 a[244:245], v12 offset:59392
    ds_read_b64_tr_b16 a[246:247], v12 offset:60416
    s_waitcnt lgkmcnt(10)
    v_mfma_f32_32x32x16_bf16 v[64:79], a[224:227], a[160:163], v[64:79]
    ds_read_b64_tr_b16 a[248:249], v12 offset:61440
    ds_read_b64_tr_b16 a[250:251], v12 offset:62464
    s_waitcnt lgkmcnt(10)
    v_mfma_f32_32x32x16_bf16 v[64:79], a[228:231], a[164:167], v[64:79]
    ds_read_b64_tr_b16 a[252:253], v12 offset:63488
    ds_read_b64_tr_b16 a[254:255], v12 offset:64512
    s_waitcnt lgkmcnt(10)
    v_mfma_f32_32x32x16_bf16 v[64:79], a[232:235], a[168:171], v[64:79]
    ds_read_b64_tr_b16 a[224:225], v16 offset:0
    ds_read_b64_tr_b16 a[226:227], v16 offset:1024
    s_waitcnt lgkmcnt(10)
    v_mfma_f32_32x32x16_bf16 v[64:79], a[236:239], a[172:175], v[64:79]
    ds_read_b64_tr_b16 a[228:229], v16 offset:2048
    ds_read_b64_tr_b16 a[230:231], v16 offset:3072
    s_waitcnt lgkmcnt(10)
    v_mfma_f32_32x32x16_bf16 v[64:79], a[240:243], a[176:179], v[64:79]
    ds_read_b64_tr_b16 a[232:233], v16 offset:4096
    ds_read_b64_tr_b16 a[234:235], v16 offset:5120
    s_waitcnt lgkmcnt(10)
    v_mfma_f32_32x32x16_bf16 v[64:79], a[244:247], a[180:183], v[64:79]
    s_cmp_eq_u32 s51, 1
    s_cbranch_scc1 L_lp_skip
    buffer_load_dword v37, v39, s[36:39], s65 offen sc1
L_lp_skip:
    ds_read_b64_tr_b16 a[236:237], v16 offset:6144
    ds_read_b64_tr_b16 a[238:239], v16 offset:7168
    s_waitcnt lgkmcnt(10)
    v_mfma_f32_32x32x16_bf16 v[64:79], a[248:251], a[184:187], v[64:79]
    ds_read_b64_tr_b16 a[240:241], v16 offset:8192
    ds_read_b64_tr_b16 a[242:243], v16 offset:9216
    s_waitcnt lgkmcnt(10)
    v_mfma_f32_32x32x16_bf16 v[64:79], a[252:255], a[188:191], v[64:79]
    ds_read_b64_tr_b16 a[244:245], v16 offset:10240
    ds_read_b64_tr_b16 a[246:247], v16 offset:11264
    s_waitcnt lgkmcnt(10)
    v_mfma_f32_32x32x16_bf16 v[64:79], a[224:227], a[192:195], v[64:79]
    ds_read_b64_tr_b16 a[248:249], v16 offset:12288
    ds_read_b64_tr_b16 a[250:251], v16 offset:13312
    s_waitcnt lgkmcnt(10)
    v_mfma_f32_32x32x16_bf16 v[64:79], a[228:231], a[196:199], v[64:79]
    ds_read_b64_tr_b16 a[252:253], v16 offset:14336
    ds_read_b64_tr_b16 a[254:255], v16 offset:15360
    s_waitcnt lgkmcnt(10)
    v_mfma_f32_32x32x16_bf16 v[64:79], a[232:235], a[200:203], v[64:79]
    s_waitcnt lgkmcnt(8)
    v_mfma_f32_32x32x16_bf16 v[64:79], a[236:239], a[204:207], v[64:79]
    s_waitcnt lgkmcnt(6)
    v_mfma_f32_32x32x16_bf16 v[64:79], a[240:243], a[208:211], v[64:79]
    s_waitcnt lgkmcnt(4)
    v_mfma_f32_32x32x16_bf16 v[64:79], a[244:247], a[212:215], v[64:79]
    s_waitcnt lgkmcnt(2)
    v_mfma_f32_32x32x16_bf16 v[64:79], a[248:251], a[216:219], v[64:79]
    s_waitcnt lgkmcnt(0)
    v_mfma_f32_32x32x16_bf16 v[64:79], a[252:255], a[220:223], v[64:79]
    s_mov_b32 s71, 0
    s_mov_b32 s63, 0xffff0000
    s_cmp_eq_u32 s51, 1
    s_cbranch_scc0 L_light_in
L_pollp:
    s_waitcnt vmcnt(6)
    v_xor_b32 v203, s70, v203
    v_xor_b32 v207, s70, v207
    v_xor_b32 v211, s70, v211
    v_or3_b32 v36, v203, v207, v211
    v_lshlrev_b32 v240, 16, v200
    v_and_b32 v241, s63, v200
    v_lshlrev_b32 v242, 16, v201
    v_and_b32 v243, s63, v201
    v_lshlrev_b32 v244, 16, v202
    v_and_b32 v245, s63, v202
    v_lshlrev_b32 v246, 16, v204
    v_and_b32 v247, s63, v204
    v_lshlrev_b32 v248, 16, v205
    v_and_b32 v249, s63, v205
    v_lshlrev_b32 v250, 16, v206
    v_and_b32 v251, s63, v206
    v_lshlrev_b32 v252, 16, v208
    v_and_b32 v253, s63, v208
    v_lshlrev_b32 v254, 16, v209
    v_and_b32 v255, s63, v209
    s_waitcnt vmcnt(3)
    v_xor_b32 v215, s70, v215
    v_xor_b32 v219, s70, v219
    v_xor_b32 v223, s70, v223
    v_or3_b32 v37, v215, v219, v223
    v_lshlrev_b32 v32, 16, v212
    v_and_b32 v212, s63, v212
    v_add_f32 v240, v240, v32
    v_add_f32 v241, v241, v212
    v_lshlrev_b32 v32, 16, v213
    v_and_b32 v213, s63, v213
    v_add_f32 v242, v242, v32
    v_add_f32 v243, v243, v213
    v_lshlrev_b32 v32, 16, v214
    v_and_b32 v214, s63, v214
    v_add_f32 v244, v244, v32
    v_add_f32 v245, v245, v214
    v_lshlrev_b32 v32, 16, v216
    v_and_b32 v216, s63, v216
    v_add_f32 v246, v246, v32
    v_add_f32 v247, v247, v216
    v_lshlrev_b32 v32, 16, v217
    v_and_b32 v217, s63, v217
    v_add_f32 v248, v248, v32
    v_add_f32 v249, v249, v217
    v_lshlrev_b32 v32, 16, v218
    v_and_b32 v218, s63, v218
    v_add_f32 v250, v250, v32
    v_add_f32 v251, v251, v218
    v_lshlrev_b32 v32, 16, v220
    v_and_b32 v220, s63, v220
    v_add_f32 v252, v252, v32
    v_add_f32 v253, v253, v220
    v_lshlrev_b32 v32, 16, v221
    v_and_b32 v221, s63, v221
    v_add_f32 v254, v254, v32
    v_add_f32 v255, v255, v221
    s_waitcnt vmcnt(0)
    v_xor_b32 v227, s70, v227
    v_xor_b32 v231, s70, v231
    v_xor_b32 v235, s70, v235
    v_or3_b32 v38, v227, v231, v235
    v_lshlrev_b32 v32, 16, v224
    v_and_b32 v224, s63, v224
    v_add_f32 v240, v240, v32
    v_add_f32 v241, v241, v224
    v_lshlrev_b32 v32, 16, v225
    v_and_b32 v225, s63, v225
    v_add_f32 v242, v242, v32
    v_add_f32 v243, v243, v225
    v_lshlrev_b32 v32, 16, v226
    v_and_b32 v226, s63, v226
    v_add_f32 v244, v244, v32
    v_add_f32 v245, v245, v226
    v_lshlrev_b32 v32, 16, v228
    v_and_b32 v228, s63, v228
    v_add_f32 v246, v246, v32
    v_add_f32 v247, v247, v228
    v_lshlrev_b32 v32, 16, v229
    v_and_b32 v229, s63, v229
    v_add_f32 v248, v248, v32
    v_add_f32 v249, v249, v229
    v_lshlrev_b32 v32, 16, v230
    v_and_b32 v230, s63, v230
    v_add_f32 v250, v250, v32
    v_add_f32 v251, v251, v230
    v_lshlrev_b32 v32, 16, v232
    v_and_b32 v232, s63, v232
    v_add_f32 v252, v252, v32
    v_add_f32 v253, v253, v232
    v_lshlrev_b32 v32, 16, v233
    v_and_b32 v233, s63, v233
    v_add_f32 v254, v254, v32
    v_add_f32 v255, v255, v233
    v_or3_b32 v36, v36, v37, v38
    v_cmp_ne_u32 vcc, 0, v36
    s_add_u32 s71, s71, 1
    s_cbranch_vccz L_pollp_ok
    s_cmp_ge_u32 s71, 65536
    s_cbranch_scc1 L_pollp_ok
L_light:
    buffer_load_dword v37, v39, s[36:39], s65 offen sc1
L_light_in:
    s_waitcnt vmcnt(0)
    v_cmp_ne_u32 vcc, s70, v37
    s_add_u32 s71, s71, 1
    s_cbranch_vccz L_light_ok
    s_cmp_lt_u32 s71, 65536
    s_cbranch_scc1 L_light
L_light_ok:
    s_add_u32 s62, s65, 32768
    buffer_load_dwordx4 v[200:203], v11, s[36:39], s62 offen sc1
    buffer_load_dwordx4 v[204:207], v11, s[36:39], s62 offen offset:1024 sc1
    buffer_load_dwordx4 v[208:211], v11, s[36:39], s62 offen offset:2048 sc1
    s_add_u32 s62, s65, 49152
    buffer_load_dwordx4 v[212:215], v11, s[36:39], s62 offen sc1
    buffer_load_dwordx4 v[216:219], v11, s[36:39], s62 offen offset:1024 sc1
    buffer_load_dwordx4 v[220:223], v11, s[36:39], s62 offen offset:2048 sc1
    s_add_u32 s62, s65, 16384
    buffer_load_dwordx4 v[224:227], v11, s[36:39], s62 offen sc1
    buffer_load_dwordx4 v[228:231], v11, s[36:39], s62 offen offset:1024 sc1
    buffer_load_dwordx4 v[232:235], v11, s[36:39], s62 offen offset:2048 sc1
    s_branch L_pollp
L_pollp_ok:
    s_nop 7
    v_add_f32 v64, v64, v240
    v_add_f32 v65, v65, v241
    v_add_f32 v66, v66, v242
    v_add_f32 v67, v67, v243
    v_add_f32 v68, v68, v244
    v_add_f32 v69, v69, v245
    v_add_f32 v70, v70, v246
    v_add_f32 v71, v71, v247
    v_add_f32 v72, v72, v248
    v_add_f32 v73, v73, v249
    v_add_f32 v74, v74, v250
    v_add_f32 v75, v75, v251
    v_add_f32 v76, v76, v252
    v_add_f32 v77, v77, v253
    v_add_f32 v78, v78, v254
    v_add_f32 v79, v79, v255
    v_cvt_pk_bf16_f32 v24, v64, v65
    v_cvt_pk_bf16_f32 v25, v66, v67
    v_cvt_pk_bf16_f32 v26, v68, v69
    v_cvt_pk_bf16_f32 v27, v70, v71
    v_cvt_pk_bf16_f32 v28, v72, v73
    v_cvt_pk_bf16_f32 v29, v74, v75
    v_cvt_pk_bf16_f32 v30, v76, v77
    v_cvt_pk_bf16_f32 v31, v78, v79
    buffer_store_dwordx4 v[24:27], v21, s[20:23], s58 offen
    buffer_store_dwordx4 v[28:31], v21, s[20:23], s58 offen offset:32
L_end:
    s_endpgm
L_rare0:
    s_nop 15
    v_mov_b32 v33, v32
    s_nop 1
    v_permlane32_swap_b32 v32, v33
    s_nop 1
    v_max_f32 v32, v32, v33
    v_max_f32 v32, 0, v32
    v_exp_f32 v33, -v32
    v_sub_f32 v64, v64, v32
    v_sub_f32 v65, v65, v32
    v_sub_f32 v66, v66, v32
    v_sub_f32 v67, v67, v32
    v_sub_f32 v68, v68, v32
    v_sub_f32 v69, v69, v32
    v_sub_f32 v70, v70, v32
    v_sub_f32 v71, v71, v32
    v_sub_f32 v72, v72, v32
    v_sub_f32 v73, v73, v32
    v_sub_f32 v74, v74, v32
    v_sub_f32 v75, v75, v32
    v_sub_f32 v76, v76, v32
    v_sub_f32 v77, v77, v32
    v_sub_f32 v78, v78, v32
    v_sub_f32 v79, v79, v32
    v_sub_f32 v80, v80, v32
    v_sub_f32 v81, v81, v32
    v_sub_f32 v82, v82, v32
    v_sub_f32 v83, v83, v32
    v_sub_f32 v84, v84, v32
    v_sub_f32 v85, v85, v32
    v_sub_f32 v86, v86, v32
    v_sub_f32 v87, v87, v32
    v_sub_f32 v88, v88, v32
    v_sub_f32 v89, v89, v32
    v_sub_f32 v90, v90, v32
    v_sub_f32 v91, v91, v32
    v_sub_f32 v92, v92, v32
    v_sub_f32 v93, v93, v32
    v_sub_f32 v94, v94, v32
    v_sub_f32 v95, v95, v32
    v_sub_f32 v240, v240, v32
    v_sub_f32 v241, v241, v32
    v_sub_f32 v242, v242, v32
    v_sub_f32 v243, v243, v32
    v_sub_f32 v244, v244, v32
    v_sub_f32 v245, v245, v32
    v_sub_f32 v246, v246, v32
    v_sub_f32 v247, v247, v32
    v_sub_f32 v248, v248, v32
    v_sub_f32 v249, v249, v32
    v_sub_f32 v250, v250, v32
    v_sub_f32 v251, v251, v32
    v_sub_f32 v252, v252, v32
    v_sub_f32 v253, v253, v32
    v_sub_f32 v254, v254, v32
    v_sub_f32 v255, v255, v32
    v_mul_f32 v160, v160, v33
    v_mul_f32 v161, v161, v33
    v_mul_f32 v162, v162, v33
    v_mul_f32 v163, v163, v33
    v_mul_f32 v164, v164, v33
    v_mul_f32 v165, v165, v33
    v_mul_f32 v166, v166, v33
    v_mul_f32 v167, v167, v33
    v_mul_f32 v168, v168, v33
    v_mul_f32 v169, v169, v33
    v_mul_f32 v170, v170, v33
    v_mul_f32 v171, v171, v33
    v_mul_f32 v172, v172, v33
    v_mul_f32 v173, v173, v33
    v_mul_f32 v174, v174, v33
    v_mul_f32 v175, v175, v33
    v_mul_f32 v176, v176, v33
    v_mul_f32 v177, v177, v33
    v_mul_f32 v178, v178, v33
    v_mul_f32 v179, v179, v33
    v_mul_f32 v180, v180, v33
    v_mul_f32 v181, v181, v33
    v_mul_f32 v182, v182, v33
    v_mul_f32 v183, v183, v33
    v_mul_f32 v184, v184, v33
    v_mul_f32 v185, v185, v33
    v_mul_f32 v186, v186, v33
    v_mul_f32 v187, v187, v33
    v_mul_f32 v188, v188, v33
    v_mul_f32 v189, v189, v33
    v_mul_f32 v190, v190, v33
    v_mul_f32 v191, v191, v33
    v_mul_f32 v192, v192, v33
    v_mul_f32 v193, v193, v33
    v_mul_f32 v194, v194, v33
    v_mul_f32 v195, v195, v33
    v_mul_f32 v196, v196, v33
    v_mul_f32 v197, v197, v33
    v_mul_f32 v198, v198, v33
    v_mul_f32 v199, v199, v33
    v_mul_f32 v200, v200, v33
    v_mul_f32 v201, v201, v33
    v_mul_f32 v202, v202, v33
    v_mul_f32 v203, v203, v33
    v_mul_f32 v204, v204, v33
    v_mul_f32 v205, v205, v33
    v_mul_f32 v206, v206, v33
    v_mul_f32 v207, v207, v33
    v_mul_f32 v208, v208, v33
    v_mul_f32 v209, v209, v33
    v_mul_f32 v210, v210, v33
    v_mul_f32 v211, v211, v33
    v_mul_f32 v212, v212, v33
    v_mul_f32 v213, v213, v33
    v_mul_f32 v214, v214, v33
    v_mul_f32 v215, v215, v33
    v_mul_f32 v216, v216, v33
    v_mul_f32 v217, v217, v33
    v_mul_f32 v218, v218, v33
    v_mul_f32 v219, v219, v33
    v_mul_f32 v220, v220, v33
    v_mul_f32 v221, v221, v33
    v_mul_f32 v222, v222, v33
    v_mul_f32 v223, v223, v33
    v_mul_f32 v224, v224, v33
    v_mul_f32 v225, v225, v33
    s_nop 3
    s_setpc_b64 s[72:73]
L_rare1:
    s_nop 15
    v_mov_b32 v33, v32
    s_nop 1
    v_permlane32_swap_b32 v32, v33
    s_nop 1
    v_max_f32 v32, v32, v33
    v_max_f32 v32, 0, v32
    v_exp_f32 v33, -v32
    v_sub_f32 v96, v96, v32
    v_sub_f32 v97, v97, v32
    v_sub_f32 v98, v98, v32
    v_sub_f32 v99, v99, v32
    v_sub_f32 v100, v100, v32
    v_sub_f32 v101, v101, v32
    v_sub_f32 v102, v102, v32
    v_sub_f32 v103, v103, v32
    v_sub_f32 v104, v104, v32
    v_sub_f32 v105, v105, v32
    v_sub_f32 v106, v106, v32
    v_sub_f32 v107, v107, v32
    v_sub_f32 v108, v108, v32
    v_sub_f32 v109, v109, v32
    v_sub_f32 v110, v110, v32
    v_sub_f32 v111, v111, v32
    v_sub_f32 v112, v112, v32
    v_sub_f32 v113, v113, v32
    v_sub_f32 v114, v114, v32
    v_sub_f32 v115, v115, v32
    v_sub_f32 v116, v116, v32
    v_sub_f32 v117, v117, v32
    v_sub_f32 v118, v118, v32
    v_sub_f32 v119, v119, v32
    v_sub_f32 v120, v120, v32
    v_sub_f32 v121, v121, v32
    v_sub_f32 v122, v122, v32
    v_sub_f32 v123, v123, v32
    v_sub_f32 v124, v124, v32
    v_sub_f32 v125, v125, v32
    v_sub_f32 v126, v126, v32
    v_sub_f32 v127, v127, v32
    v_sub_f32 v240, v240, v32
    v_sub_f32 v241, v241, v32
    v_sub_f32 v242, v242, v32
    v_sub_f32 v243, v243, v32
    v_sub_f32 v244, v244, v32
    v_sub_f32 v245, v245, v32
    v_sub_f32 v246, v246, v32
    v_sub_f32 v247, v247, v32
    v_sub_f32 v248, v248, v32
    v_sub_f32 v249, v249, v32
    v_sub_f32 v250, v250, v32
    v_sub_f32 v251, v251, v32
    v_sub_f32 v252, v252, v32
    v_sub_f32 v253, v253, v32
    v_sub_f32 v254, v254, v32
    v_sub_f32 v255, v255, v32
    v_mul_f32 v160, v160, v33
    v_mul_f32 v161, v161, v33
    v_mul_f32 v162, v162, v33
    v_mul_f32 v163, v163, v33
    v_mul_f32 v164, v164, v33
    v_mul_f32 v165, v165, v33
    v_mul_f32 v166, v166, v33
    v_mul_f32 v167, v167, v33
    v_mul_f32 v168, v168, v33
    v_mul_f32 v169, v169, v33
    v_mul_f32 v170, v170, v33
    v_mul_f32 v171, v171, v33
    v_mul_f32 v172, v172, v33
    v_mul_f32 v173, v173, v33
    v_mul_f32 v174, v174, v33
    v_mul_f32 v175, v175, v33
    v_mul_f32 v176, v176, v33
    v_mul_f32 v177, v177, v33
    v_mul_f32 v178, v178, v33
    v_mul_f32 v179, v179, v33
    v_mul_f32 v180, v180, v33
    v_mul_f32 v181, v181, v33
    v_mul_f32 v182, v182, v33
    v_mul_f32 v183, v183, v33
    v_mul_f32 v184, v184, v33
    v_mul_f32 v185, v185, v33
    v_mul_f32 v186, v186, v33
    v_mul_f32 v187, v187, v33
    v_mul_f32 v188, v188, v33
    v_mul_f32 v189, v189, v33
    v_mul_f32 v190, v190, v33
    v_mul_f32 v191, v191, v33
    v_mul_f32 v192, v192, v33
    v_mul_f32 v193, v193, v33
    v_mul_f32 v194, v194, v33
    v_mul_f32 v195, v195, v33
    v_mul_f32 v196, v196, v33
    v_mul_f32 v197, v197, v33
    v_mul_f32 v198, v198, v33
    v_mul_f32 v199, v199, v33
    v_mul_f32 v200, v200, v33
    v_mul_f32 v201, v201, v33
    v_mul_f32 v202, v202, v33
    v_mul_f32 v203, v203, v33
    v_mul_f32 v204, v204, v33
    v_mul_f32 v205, v205, v33
    v_mul_f32 v206, v206, v33
    v_mul_f32 v207, v207, v33
    v_mul_f32 v208, v208, v33
    v_mul_f32 v209, v209, v33
    v_mul_f32 v210, v210, v33
    v_mul_f32 v211, v211, v33
    v_mul_f32 v212, v212, v33
    v_mul_f32 v213, v213, v33
    v_mul_f32 v214, v214, v33
    v_mul_f32 v215, v215, v33
    v_mul_f32 v216, v216, v33
    v_mul_f32 v217, v217, v33
    v_mul_f32 v218, v218, v33
    v_mul_f32 v219, v219, v33
    v_mul_f32 v220, v220, v33
    v_mul_f32 v221, v221, v33
    v_mul_f32 v222, v222, v33
    v_mul_f32 v223, v223, v33
    v_mul_f32 v224, v224, v33
    v_mul_f32 v225, v225, v33
    s_nop 3
    s_setpc_b64 s[72:73]
L_oslow0:
    buffer_store_dwordx4 v[128:131], v11, s[36:39], s44 offen sc1
    buffer_store_dwordx4 v[132:135], v11, s[36:39], s44 offen offset:1024 sc1
    s_branch L_odone0
L_oslow1:
    buffer_store_dwordx4 v[136:139], v11, s[36:39], s44 offen offset:2048 sc1
    buffer_store_dwordx4 v[140:143], v11, s[36:39], s44 offen offset:3072 sc1
    s_branch L_odone1
L_oslow2:
    buffer_store_dwordx4 v[144:147], v11, s[36:39], s46 offen sc1
    buffer_store_dwordx4 v[148:151], v11, s[36:39], s46 offen offset:1024 sc1
    s_branch L_odone2
L_oslow3:
    buffer_store_dwordx4 v[152:155], v11, s[36:39], s46 offen offset:2048 sc1
    buffer_store_dwordx4 v[156:159], v11, s[36:39], s46 offen offset:3072 sc1
    s_branch L_odone3
L_fslow:
    buffer_store_dword v35, v34, s[36:39], s48 offen sc1
    s_branch L_fdone
L_code_end:
.section .rodata,"a"
.p2align 6
.amdhsa_kernel standalone__mha_block_cached__near_ridge_kernel
  .amdhsa_next_free_vgpr 512
  .amdhsa_next_free_sgpr 102
  .amdhsa_accum_offset 256
  .amdhsa_group_segment_fixed_size 0
  .amdhsa_kernarg_size 64
  .amdhsa_user_sgpr_count 2
  .amdhsa_user_sgpr_kernarg_segment_ptr 1
  .amdhsa_system_sgpr_workgroup_id_x 1
.end_amdhsa_kernel
```
